```python
import torch

def _softmax(x, axis=-1):
    return torch.softmax(x, dim=axis)
def _gelu(x):
    return torch.nn.functional.gelu(x, approximate="tanh")
def _silu(x):
    return torch.nn.functional.silu(x)
def _sigmoid(x):
    return torch.sigmoid(x)
def _layernorm(x, axis=-1, eps=1e-5):
    m = x.mean(dim=axis, keepdim=True)
    v = x.var(dim=axis, keepdim=True, unbiased=False)
    return (x - m) / torch.sqrt(v + eps)
def _scatter_add(tgt, idx, src, axis=0):
    return tgt.clone().index_add_(axis, idx, src)
def _segment_sum(src, seg, n):
    out = torch.zeros((n,) + src.shape[1:], dtype=src.dtype)
    return out.index_add_(0, seg, src)
def _pad(x, pw):
    flat = tuple(v for pair in reversed(pw) for v in pair)
    return torch.nn.functional.pad(x, flat)

kernel_name = 'gated_mix__ssm_conv_s5__glu_gated_bilinear__prompt'

def setup_inputs():

    _w = (lambda a: (lambda t: t.to(torch.bfloat16) if t.is_floating_point() else t)(torch.as_tensor(a)))
    def _A_setup():
        B, S, D = 1, 2048, 512
        P = D
        Lambda_re = -0.5 * (lambda _x: torch.exp(torch.as_tensor(_x)))((lambda *s: torch.randn(*s, dtype=torch.bfloat16) * 0.2)(P))
        Lambda_im = (lambda *s: torch.randn(*s, dtype=torch.bfloat16) * 0.4)(P) * 1.0
        B_re = (lambda *s: torch.randn(*s, dtype=torch.bfloat16) * 0.2)(P, D) * (D ** -0.5)
        B_im = (lambda *s: torch.randn(*s, dtype=torch.bfloat16) * 0.2)(P, D) * (D ** -0.5)
        C_re = (lambda *s: torch.randn(*s, dtype=torch.bfloat16) * 0.2)(D, P) * (P ** -0.5)
        C_im = (lambda *s: torch.randn(*s, dtype=torch.bfloat16) * 0.2)(D, P) * (P ** -0.5)
        log_dt = (lambda *s: torch.randn(*s, dtype=torch.bfloat16) * 0.2)(P) * 0.3 - 2.0
        Dskip = (lambda *s: torch.randn(*s, dtype=torch.bfloat16) * 0.05)(D)
        return {
            "x": _w((lambda *s: torch.randn(*s, dtype=torch.bfloat16) * 0.05)(B, S, D)),
            "Lambda_re": _w(Lambda_re),
            "Lambda_im": _w(Lambda_im),
            "B_re": _w(B_re),
            "B_im": _w(B_im),
            "C_re": _w(C_re),
            "C_im": _w(C_im),
            "log_dt": _w(log_dt),
            "Dskip": _w(Dskip),
        }
    _A_in = _A_setup()

    def _B_setup():
        B, S, D, F = 1, 2048, 512, 1376
        return {
            "x": _w((lambda *s: torch.randn(*s, dtype=torch.bfloat16) * 0.05)(B, S, D)),
            "w_gate": _w((lambda *s: torch.randn(*s, dtype=torch.bfloat16) * 0.8)(D, F) * (D ** -0.5)),
            "w_up": _w((lambda *s: torch.randn(*s, dtype=torch.bfloat16) * 0.8)(D, F) * (D ** -0.5)),
            "w_down": _w((lambda *s: torch.randn(*s, dtype=torch.bfloat16) * 0.8)(F, D) * (F ** -0.5)),
        }
    _B_in = _B_setup()

    return {
        "A_x": _A_in["x"],
        "A_Lambda_re": _A_in["Lambda_re"],
        "A_Lambda_im": _A_in["Lambda_im"],
        "A_B_re": _A_in["B_re"],
        "A_B_im": _A_in["B_im"],
        "A_C_re": _A_in["C_re"],
        "A_C_im": _A_in["C_im"],
        "A_log_dt": _A_in["log_dt"],
        "A_Dskip": _A_in["Dskip"],
        "B_x": _B_in["x"],
        "B_w_gate": _B_in["w_gate"],
        "B_w_up": _B_in["w_up"],
        "B_w_down": _B_in["w_down"],
        "gate_w": _w((lambda *s: torch.randn(*s, dtype=torch.bfloat16) * 0.05)(512) * 16.0),
    }

def reference(A_x, A_Lambda_re, A_Lambda_im, A_B_re, A_B_im, A_C_re, A_C_im, A_log_dt, A_Dskip, B_x, B_w_gate, B_w_up, B_w_down, gate_w):
    def _A_ref(x, Lambda_re, Lambda_im, B_re, B_im, C_re, C_im, log_dt, Dskip):
        Bsz, L, H = x.shape
        Lam = Lambda_re + 1j * Lambda_im
        Bmat = B_re + 1j * B_im
        Cmat = C_re + 1j * C_im
        dt = torch.exp(log_dt)
        Lam_bar = torch.exp(dt * Lam)
        B_bar = ((Lam_bar - 1.0) / Lam)[:, None] * Bmat
        Bu = torch.einsum("bld,pd->blp", x + 0j, B_bar)
        h = torch.zeros_like(Bu[:, 0, :])
        hs = []
        for t in range(L):
            h = Lam_bar[None, :] * h + Bu[:, t, :]
            hs.append(h)
        hseq = torch.stack(hs, 1)
        y = 2.0 * torch.einsum("blp,dp->bld", hseq, Cmat).real + x * Dskip[None, None, :]
        return y

    def _B_ref(x, w_gate, w_up, w_down):
        g = torch.einsum("bsd,df->bsf", x, w_gate)
        u = torch.einsum("bsd,df->bsf", x, w_up)
        h = g * u
        return torch.einsum("bsf,fd->bsd", h, w_down)

    x = A_x
    g = _sigmoid((x * gate_w).sum(-1, keepdims=True))
    a = _A_ref(x, A_Lambda_re, A_Lambda_im, A_B_re, A_B_im, A_C_re, A_C_im, A_log_dt, A_Dskip)
    b = _B_ref(x, B_w_gate, B_w_up, B_w_down)
    return g * a + (1 - g) * b
```

```asm
; @launch grid=(256,1,1) block=(256,1,1) lds=163840
.amdgcn_target "amdgcn-amd-amdhsa--gfx950"
.text

.globl gated_mix__ssm_conv_s5__glu_gated_bilinear__prompt_kernel
.p2align 8
.type gated_mix__ssm_conv_s5__glu_gated_bilinear__prompt_kernel,@function
gated_mix__ssm_conv_s5__glu_gated_bilinear__prompt_kernel:

    s_cmp_ge_u32 s2, 256
    s_cbranch_scc1 L_end
    s_getpc_b64 s[72:73]
L_pc:
    v_lshlrev_b32 v26, 7, v0
    v_min_u32 v26, L_end-L_pc, v26
    global_load_dword v51, v26, s[72:73]
    s_load_dwordx2 s[8:9], s[0:1], 0
    s_load_dwordx4 s[12:15], s[0:1], 24
    s_load_dwordx4 s[52:55], s[0:1], 8
    s_load_dwordx2 s[56:57], s[0:1], 56
    s_load_dwordx2 s[58:59], s[0:1], 104
    s_load_dwordx2 s[28:29], s[0:1], 128
    v_lshrrev_b32 v1, 6, v0
    s_and_b32 s66, s2, 7
    v_readfirstlane_b32 s3, v1
    v_and_b32 v1, 63, v0
    s_lshr_b32 s83, s2, 3
    s_lshl_b32 s6, s66, 2
    s_lshr_b32 s72, s83, 3
    s_add_u32 s6, s6, s72
    s_and_b32 s7, s83, 7
    s_lshr_b32 s5, s66, 1
    s_and_b32 s73, s66, 1
    s_lshl_b32 s4, s73, 3
    s_add_u32 s4, s4, s7
    s_lshl_b32 s73, s73, 1
    s_add_u32 s63, s5, s73
    s_and_b32 s63, s63, 3
    s_lshl_b32 s63, s63, 8
    s_lshl_b32 s5, s5, 2
    s_add_u32 s5, s5, s72
    s_and_b32 s63, s63, 512
    s_lshl_b32 s65, s4, 2
    s_add_u32 s65, s65, s3
    s_lshl_b32 s78, s3, 12
    v_lshlrev_b32 v26, 5, v0
    v_and_b32 v26, 0x1f80, v26
    s_and_b32 s72, s66, 1
    s_lshr_b32 s73, s66, 1
    s_lshl2_add_u32 s72, s72, s73
    s_lshl_b32 s72, s72, 5
    s_add_u32 s72, s72, s83
    s_lshl_b32 s72, s72, 13
    v_add_u32 v27, s72, v26
    s_waitcnt lgkmcnt(0)
    s_lshl_b32 s72, s66, 5
    s_add_u32 s72, s72, s83
    s_lshl_b32 s72, s72, 11
    v_lshrrev_b32 v27, 2, v26
    v_and_b32 v27, 0x780, v27
    v_add_u32 v27, s72, v27
    global_load_dword v51, v27, s[12:13]
    global_load_dword v51, v27, s[14:15]
    v_lshrrev_b32 v28, 4, v1
    v_and_b32 v29, 7, v1
    v_xor_b32 v28, v28, v29
    v_lshlrev_b32 v31, 4, v28
    v_lshrrev_b32 v29, 5, v1
    v_and_b32 v30, 8, v1
    v_lshl_add_u32 v29, v29, 4, v30
    v_bfe_u32 v30, v1, 4, 1
    v_add_u32 v29, v29, v30
    s_lshl_b32 s72, s65, 15
    v_lshl_add_u32 v29, v29, 10, v31
    v_add_u32 v2, s72, v29
    v_xor_b32 v3, 64, v2
    v_add_u32 v4, 2048, v2
    v_add_u32 v5, 3072, v3
    v_add_u32 v3, 1024, v3
    s_mov_b32 s10, 2097152
    s_mov_b32 s11, 0x20000
    s_add_u32 m0, s78, 98432
    s_mul_i32 s64, s63, 1376
    s_waitcnt lgkmcnt(0)
    buffer_load_dwordx4 v2, s[8:11], s63 offen offset:0 lds
    buffer_load_dwordx4 v3, s[8:11], s63 offen offset:1024 lds
    buffer_load_dwordx4 v4, s[8:11], s63 offen offset:2048 lds
    buffer_load_dwordx4 v5, s[8:11], s63 offen offset:3072 lds
    v_lshlrev_b32 v23, 4, v1
    v_and_b32 v28, 31, v1
    s_lshl_b32 s72, s5, 6
    v_lshl_add_u32 v28, v28, 1, s72
    global_load_ushort v36, v28, s[52:53]
    global_load_ushort v37, v28, s[54:55]
    global_load_ushort v38, v28, s[56:57]
    global_load_dwordx4 v[160:163], v23, s[58:59]
    s_lshl_b32 s72, s5, 11
    s_lshl_b32 s73, s65, 15
    s_add_u32 s72, s72, s73
    buffer_load_dwordx4 v[164:167], v23, s[8:11], s72 offen
    buffer_load_dwordx4 v[168:171], v23, s[8:11], s72 offen offset:1024
    s_add_u32 s74, s28, 13631488
    s_addc_u32 s75, s29, 0
    s_load_dword s62, s[74:75], 0
    s_load_dwordx2 s[20:21], s[0:1], 80
    s_load_dwordx2 s[24:25], s[0:1], 88
    s_load_dwordx2 s[36:37], s[0:1], 40
    s_load_dwordx2 s[40:41], s[0:1], 48
    s_load_dwordx2 s[44:45], s[0:1], 96
    s_load_dwordx2 s[48:49], s[0:1], 112
    s_load_dwordx2 s[60:61], s[0:1], 64
    v_lshrrev_b32 v29, 3, v1
    v_lshl_add_u32 v52, v29, 10, v31
    s_lshl_b32 s79, s3, 11
    s_and_b32 s72, s3, 1
    s_lshl_b32 s72, s72, 6
    v_xor_b32 v6, s72, v52
    s_lshl_b32 s72, s5, 2
    s_add_u32 s72, s72, s3
    s_lshl_b32 s72, s72, 13
    v_add_u32 v6, s72, v6
    s_sub_u32 s16, s14, 1024
    s_subb_u32 s17, s15, 0
    s_mov_b32 s14, 524288
    s_mov_b32 s15, 0x20000
    s_mov_b32 s18, 525312
    s_mov_b32 s19, 0x20000
    s_add_u32 m0, s79, 114816
    s_nop 0
    buffer_load_dwordx4 v6, s[12:15], s63 offen lds
    buffer_load_dwordx4 v6, s[16:19], s63 offen offset:1024 lds
    s_mul_i32 s73, s5, 43
    s_add_u32 m0, s78, 123040
    s_add_u32 s63, s63, 128
    s_and_b32 s63, s63, 1023
    buffer_load_dwordx4 v2, s[8:11], s63 offen offset:0 lds
    s_lshr_b32 s68, s73, 4
    s_add_u32 s73, s73, 43
    s_lshr_b32 s73, s73, 4
    s_sub_u32 s73, s73, s68
    s_cmp_eq_u32 s73, 2
    s_cselect_b32 s74, 1073741824, 0
    s_mul_i32 s80, s3, 3072
    s_mul_i32 s72, s3, 44032
    s_lshl_b32 s73, s68, 6
    s_add_u32 s72, s72, s73
    v_mov_b32 v32, s74
    v_add_u32 v28, 0, v1
    v_mul_u32_u24 v29, 0x5556, v28
    v_lshrrev_b32 v29, 18, v29
    v_mul_u32_u24 v30, 12, v29
    v_sub_u32 v28, v28, v30
    v_cmp_lt_u32 vcc, 7, v28
    v_mul_u32_u24 v29, 2560, v29
    buffer_load_dwordx4 v3, s[8:11], s63 offen offset:1024 lds
    v_lshl_add_u32 v29, v1, 4, v29
    v_cndmask_b32 v28, 0, v32, vcc
    v_add3_u32 v7, s72, v29, v28
    v_add_u32 v28, 64, v1
    v_mul_u32_u24 v29, 0x5556, v28
    v_lshrrev_b32 v29, 18, v29
    v_mul_u32_u24 v30, 12, v29
    v_sub_u32 v28, v28, v30
    v_cmp_lt_u32 vcc, 7, v28
    v_mul_u32_u24 v29, 2560, v29
    v_lshl_add_u32 v29, v1, 4, v29
    v_cndmask_b32 v28, 0, v32, vcc
    v_add3_u32 v8, s72, v29, v28
    v_add_u32 v28, 128, v1
    v_mul_u32_u24 v29, 0x5556, v28
    v_lshrrev_b32 v29, 18, v29
    v_mul_u32_u24 v30, 12, v29
    buffer_load_dwordx4 v4, s[8:11], s63 offen offset:2048 lds
    v_sub_u32 v28, v28, v30
    v_cmp_lt_u32 vcc, 7, v28
    v_mul_u32_u24 v29, 2560, v29
    v_lshl_add_u32 v29, v1, 4, v29
    v_cndmask_b32 v28, 0, v32, vcc
    v_add3_u32 v9, s72, v29, v28
    v_lshlrev_b32 v23, 4, v1
    s_waitcnt lgkmcnt(0)
    s_mov_b32 s22, 1409024
    s_mov_b32 s23, 0x20000
    s_mov_b32 s26, 1409024
    s_mov_b32 s27, 0x20000
    v_bfe_u32 v26, v1, 1, 3
    v_lshrrev_b32 v27, 5, v1
    v_xor_b32 v26, v26, v27
    v_lshlrev_b32 v26, 4, v26
    v_and_b32 v28, 31, v1
    buffer_load_dwordx4 v5, s[8:11], s63 offen offset:3072 lds
    s_add_u32 m0, s79, 139424
    s_nop 0
    v_lshl_add_u32 v18, v28, 7, v26
    v_bfe_u32 v26, v1, 3, 2
    v_lshlrev_b32 v26, 10, v26
    v_add_u32 v26, 90208, v26
    s_add_u32 s72, s78, 73824
    s_xor_b32 s73, s78, 4096
    s_add_u32 s73, s73, 73824
    v_xor_b32 v21, 96, v18
    v_add_u32 v13, s72, v21
    v_add_u32 v17, s73, v21
    v_add_u32 v21, v26, v21
    v_xor_b32 v20, 64, v18
    v_add_u32 v12, s72, v20
    v_add_u32 v16, s73, v20
    v_add_u32 v20, v26, v20
    v_xor_b32 v19, 32, v18
    buffer_load_dwordx4 v6, s[12:15], s63 offen lds
    v_add_u32 v11, s72, v19
    v_add_u32 v15, s73, v19
    v_add_u32 v19, v26, v19
    v_add_u32 v10, s72, v18
    v_add_u32 v14, s73, v18
    v_add_u32 v18, v26, v18
    v_lshlrev_b32 v28, 3, v27
    v_bfe_u32 v29, v1, 2, 2
    v_add_u32 v28, v28, v29
    v_mul_u32_u24 v28, 192, v28
    v_bfe_u32 v29, v1, 4, 1
    v_mul_u32_u24 v29, 12320, v29
    v_add_u32 v28, v28, v29
    v_and_b32 v29, 3, v1
    v_lshl_add_u32 v22, v29, 3, v28
    s_and_b32 s72, s3, 1
    s_mul_i32 s72, s72, 96
    s_add_u32 s72, s72, 0
    buffer_load_dwordx4 v6, s[16:19], s63 offen offset:1024 lds
    s_add_u32 m0, s78, 73824
    s_add_u32 s63, s63, 128
    s_and_b32 s63, s63, 1023
    v_add_u32 v22, s72, v22
    s_mov_b32 s30, 268435456
    s_mov_b32 s31, 0x20000
    s_mov_b32 s38, 524288
    s_mov_b32 s39, 0x20000
    s_mov_b32 s42, 524288
    s_mov_b32 s43, 0x20000
    s_mov_b32 s46, 1409024
    s_mov_b32 s47, 0x20000
    s_mov_b32 s50, 4194304
    s_mov_b32 s51, 0x20000
    s_lshl_b32 s53, s5, 4
    s_sub_u32 s53, s53, s4
    buffer_load_dwordx4 v2, s[8:11], s63 offen offset:0 lds
    s_lshl_b32 s53, s53, 9
    s_add_u32 s53, s53, 10493952
    s_add_u32 s32, s28, s53
    s_addc_u32 s33, s29, 0
    s_lshl_b32 s34, s4, 9
    s_mov_b32 s35, 0x20000
    s_sub_u32 s53, s53, 512
    s_mul_i32 s67, s65, 163840
    s_nop 0
    s_lshr_b32 s54, s5, 2
    s_and_b32 s7, s5, 3
    s_lshl_b32 s57, s7, 2
    s_add_u32 s57, s57, s54
    s_lshl_b32 s57, s57, 5
    s_xor_b32 s72, s3, s54
    s_lshl_b32 s72, s72, 15
    s_lshl_b32 s73, s7, 17
    s_add_u32 s72, s72, s73
    buffer_load_dwordx4 v3, s[8:11], s63 offen offset:1024 lds
    s_lshl_b32 s73, s54, 8
    s_add_u32 s72, s72, s73
    v_add_u32 v52, s72, v52
    v_xor_b32 v53, 64, v52
    v_add_u32 v54, 14336, v52
    v_add_u32 v55, 21504, v53
    v_add_u32 v53, 7168, v53
    v_bfe_u32 v26, v1, 4, 1
    v_lshlrev_b32 v26, 2, v26
    v_and_b32 v27, 7, v1
    v_xor_b32 v26, v26, v27
    v_lshlrev_b32 v26, 4, v26
    v_lshrrev_b32 v28, 3, v1
    v_lshl_add_u32 v26, v28, 10, v26
    s_lshl_b32 s72, s7, 8
    s_lshr_b32 s73, s54, 1
    s_lshl_b32 s73, s73, 7
    s_add_u32 s72, s72, s73
    buffer_load_dwordx4 v4, s[8:11], s63 offen offset:2048 lds
    s_add_u32 s72, s72, 4096
    v_add_u32 v56, s72, v26
    v_xor_b32 v58, 128, v56
    v_add_u32 v57, 7168, v56
    v_add_u32 v59, 5120, v58
    v_subrev_u32 v58, 2048, v58
    s_mul_i32 s59, s54, 172
    s_lshr_b32 s59, s59, 4
    s_lshl_b32 s59, s59, 1
    s_and_b32 s73, s3, 1
    s_mul_i32 s73, s73, 3
    s_lshr_b32 s72, s3, 1
    s_add_u32 s72, s72, 4
    s_sub_u32 s72, s72, s54
    s_and_b32 s72, s72, 3
    s_lshl2_add_u32 s72, s54, s72
    s_mul_i32 s72, s72, 43
    s_lshr_b32 s72, s72, 4
    buffer_load_dwordx4 v5, s[8:11], s63 offen offset:3072 lds
    s_add_u32 m0, s79, 90208
    s_nop 0
    s_lshl1_add_u32 s72, s72, s73
    s_lshl_b32 s55, s72, 14
    s_lshr_b32 s72, s3, 1
    s_add_u32 s72, s72, 6
    s_sub_u32 s72, s72, s54
    s_and_b32 s72, s72, 3
    s_lshl2_add_u32 s72, s54, s72
    s_mul_i32 s72, s72, 43
    s_lshr_b32 s72, s72, 4
    s_lshl1_add_u32 s72, s72, s73
    s_lshl_b32 s56, s72, 14
    v_lshrrev_b32 v26, 5, v1
    v_lshlrev_b32 v26, 2, v26
    v_bfe_u32 v27, v1, 2, 2
    v_add_u32 v26, v26, v27
    v_lshlrev_b32 v26, 7, v26
    v_bfe_u32 v27, v1, 3, 1
    buffer_load_dwordx4 v6, s[12:15], s63 offen lds
    v_lshl_add_u32 v26, v27, 6, v26
    v_bfe_u32 v27, v1, 4, 1
    v_lshl_add_u32 v26, v27, 5, v26
    v_and_b32 v27, 3, v1
    v_lshl_add_u32 v26, v27, 3, v26
    s_and_b32 s72, s54, 1
    s_lshl_b32 s72, s72, 6
    v_xor_b32 v60, s72, v26
    v_xor_b32 v61, 64, v60
    v_add_u32 v62, 65600, v60
    v_add_u32 v63, 65600, v61
    s_lshl_b32 s52, s3, 3
    s_waitcnt vmcnt(13)
    v_dot2_f32_bf16 v32, v160, v164, 0
    v_dot2_f32_bf16 v33, v160, v168, 0
    v_dot2_f32_bf16 v32, v161, v165, v32
    v_dot2_f32_bf16 v33, v161, v169, v33
    v_dot2_f32_bf16 v32, v162, v166, v32
    buffer_load_dwordx4 v6, s[16:19], s63 offen offset:1024 lds
    s_add_u32 m0, s78, 0
    s_add_u32 s63, s63, 128
    s_and_b32 s63, s63, 1023
    v_dot2_f32_bf16 v33, v162, v170, v33
    v_dot2_f32_bf16 v32, v163, v167, v32
    v_dot2_f32_bf16 v33, v163, v171, v33
    s_nop 2
    v_permlane32_swap_b32 v32, v33
    s_nop 1
    v_add_f32 v34, v32, v33
    s_nop 1
    v_add_f32_dpp v34, v34, v34 quad_perm:[1,0,3,2] row_mask:0xf bank_mask:0xf
    s_nop 1
    v_add_f32_dpp v34, v34, v34 quad_perm:[2,3,0,1] row_mask:0xf bank_mask:0xf
    buffer_load_dwordx4 v2, s[8:11], s63 offen offset:0 lds
    s_nop 1
    v_add_f32_dpp v34, v34, v34 row_half_mirror row_mask:0xf bank_mask:0xf
    s_nop 1
    v_add_f32_dpp v34, v34, v34 row_mirror row_mask:0xf bank_mask:0xf
    v_mov_b32 v35, v34
    s_nop 1
    v_permlane16_swap_b32 v34, v35
    s_nop 1
    v_add_f32 v34, v34, v35
    v_cvt_pk_bf16_f32 v34, v34, v34
    v_lshlrev_b32 v34, 16, v34
    v_mul_f32 v34, 0xbfb8aa3b, v34
    v_exp_f32 v34, v34
    s_nop 0
    buffer_load_dwordx4 v3, s[8:11], s63 offen offset:1024 lds
    v_add_f32 v34, 1.0, v34
    v_rcp_f32 v34, v34
    buffer_load_dwordx4 v4, s[8:11], s63 offen offset:2048 lds
    buffer_load_dwordx4 v5, s[8:11], s63 offen offset:3072 lds
    s_add_u32 m0, s79, 16384
    s_nop 0
    buffer_load_dwordx4 v6, s[12:15], s63 offen lds
    buffer_load_dwordx4 v6, s[16:19], s63 offen offset:1024 lds
    s_waitcnt vmcnt(18)
    s_barrier
    ds_read_b128 a[0:3], v10 offset:24608
    s_add_u32 m0, s78, 24608
    s_add_u32 s63, s63, 128
    s_and_b32 s63, s63, 1023
    buffer_load_dwordx4 v2, s[8:11], s63 offen offset:0 lds
    ds_read_b128 v[64:67], v18 offset:24608
    ds_read_b128 v[68:71], v18 offset:25632
    ds_read_b128 a[4:7], v14 offset:24608
    ds_read_b128 a[8:11], v11 offset:24608
    ds_read_b128 v[72:75], v19 offset:24608
    ds_read_b128 v[76:79], v19 offset:25632
    buffer_load_dwordx4 v3, s[8:11], s63 offen offset:1024 lds
    ds_read_b128 a[12:15], v15 offset:24608
    ds_read_b128 a[16:19], v12 offset:24608
    ds_read_b128 v[80:83], v20 offset:24608
    ds_read_b128 v[84:87], v20 offset:25632
    ds_read_b128 a[20:23], v16 offset:24608
    s_waitcnt lgkmcnt(9)
    buffer_load_dwordx4 v4, s[8:11], s63 offen offset:2048 lds
    v_mfma_f32_32x32x16_bf16 v[128:143], a[0:3], v[64:67], 0
    ds_read_b128 a[24:27], v13 offset:24608
    ds_read_b128 v[88:91], v21 offset:24608
    ds_read_b128 v[92:95], v21 offset:25632
    ds_read_b128 a[28:31], v17 offset:24608
    s_mul_i32 s77, s2, 5504
    buffer_load_dwordx4 v5, s[8:11], s63 offen offset:3072 lds
    s_add_u32 m0, s79, 40992
    s_nop 0
    v_lshlrev_b32 v48, 5, v0
    v_mfma_f32_32x32x16_bf16 v[144:159], a[0:3], v[68:71], 0
    v_and_b32 v48, 0x1f80, v48
    s_waitcnt lgkmcnt(9)
    v_mfma_f32_32x32x16_bf16 v[128:143], a[8:11], v[72:75], v[128:143]
    buffer_load_dwordx4 v6, s[12:15], s63 offen lds
    v_min_u32 v48, 5376, v48
    buffer_load_dword v51, v48, s[20:23], s77 offen
    s_nop 0
    v_cvt_pk_bf16_f32 v34, v34, v34
    v_mfma_f32_32x32x16_bf16 v[144:159], a[8:11], v[76:79], v[144:159]
    s_waitcnt vmcnt(18) lgkmcnt(0)
    s_barrier
    ds_read_b128 a[32:35], v10 offset:49216
    ds_read_b128 v[96:99], v18 offset:49216
    ds_read_b128 v[100:103], v18 offset:50240
    ds_read_b128 a[36:39], v14 offset:49216
    buffer_load_dword v51, v48, s[24:27], s77 offen
    v_mfma_f32_32x32x16_bf16 v[128:143], a[16:19], v[80:83], v[128:143]
    ds_read_b128 a[40:43], v11 offset:49216
    ds_read_b128 v[64:67], v19 offset:49216
    ds_read_b128 v[68:71], v19 offset:50240
    ds_read_b128 a[44:47], v15 offset:49216
    v_mfma_f32_32x32x16_bf16 v[144:159], a[16:19], v[84:87], v[144:159]
    ds_read_b128 a[48:51], v12 offset:49216
    v_lshlrev_b32 v34, 16, v34
    s_add_u32 s62, s62, 1
    v_mov_b32 v24, s62
    v_mfma_f32_32x32x16_bf16 v[128:143], a[24:27], v[88:91], v[128:143]
    buffer_load_dwordx4 v6, s[16:19], s63 offen offset:1024 lds
    s_add_u32 m0, s78, 49216
    s_add_u32 s63, s63, 128
    s_and_b32 s63, s63, 1023
    ds_read_b128 v[72:75], v20 offset:49216
    ds_read_b128 v[76:79], v20 offset:50240
    ds_read_b128 a[52:55], v16 offset:49216
    v_mfma_f32_32x32x16_bf16 v[144:159], a[24:27], v[92:95], v[144:159]
    buffer_load_dwordx4 v2, s[8:11], s63 offen offset:0 lds
    v_mov_b32 v35, s62
    v_lshrrev_b32 v26, 5, v1
    v_lshlrev_b32 v26, 3, v26
    s_lshl_b32 s72, s65, 8
    s_lshl_b32 s73, s5, 4
    s_add_u32 s72, s72, s73
    s_waitcnt lgkmcnt(9)
    v_mfma_f32_32x32x16_bf16 v[128:143], a[32:35], v[96:99], v[128:143]
    ds_read_b128 a[56:59], v13 offset:49216
    ds_read_b128 v[80:83], v21 offset:49216
    buffer_load_dwordx4 v3, s[8:11], s63 offen offset:1024 lds
    ds_read_b128 v[84:87], v21 offset:50240
    ds_read_b128 a[60:63], v17 offset:49216
    v_mfma_f32_32x32x16_bf16 v[144:159], a[32:35], v[100:103], v[144:159]
    s_add_u32 s72, s72, 11534336
    buffer_store_dwordx2 v[34:35], v26, s[28:31], s72 offen sc1
    v_lshlrev_b32 v36, 16, v36
    v_lshlrev_b32 v37, 16, v37
    s_waitcnt lgkmcnt(9)
    v_mfma_f32_32x32x16_bf16 v[128:143], a[40:43], v[64:67], v[128:143]
    v_lshlrev_b32 v38, 16, v38
    v_mul_f32 v26, 0x3fb8aa3b, v38
    v_exp_f32 v26, v26
    s_nop 0
    v_mfma_f32_32x32x16_bf16 v[144:159], a[40:43], v[68:71], v[144:159]
    s_waitcnt vmcnt(17) lgkmcnt(0)
    buffer_load_dwordx4 v4, s[8:11], s63 offen offset:2048 lds
    s_barrier
    ds_read_b128 a[64:67], v10 offset:0
    ds_read_b128 v[88:91], v18 offset:0
    ds_read_b128 v[92:95], v18 offset:1024
    buffer_load_dwordx4 v5, s[8:11], s63 offen offset:3072 lds
    s_add_u32 m0, s79, 65600
    s_nop 0
    ds_read_b128 a[68:71], v14 offset:0
    v_mfma_f32_32x32x16_bf16 v[128:143], a[48:51], v[72:75], v[128:143]
    ds_read_b128 a[72:75], v11 offset:0
    ds_read_b128 v[96:99], v19 offset:0
    ds_read_b128 v[100:103], v19 offset:1024
    buffer_load_dwordx4 v6, s[12:15], s63 offen lds
    ds_read_b128 a[76:79], v15 offset:0
    v_mfma_f32_32x32x16_bf16 v[144:159], a[48:51], v[76:79], v[144:159]
    ds_read_b128 a[80:83], v12 offset:0
    v_cvt_pk_bf16_f32 v26, v26, v26
    v_lshlrev_b32 v26, 16, v26
    v_mul_f32 v27, v26, v36
    v_mfma_f32_32x32x16_bf16 v[128:143], a[56:59], v[80:83], v[128:143]
    buffer_load_dwordx4 v6, s[16:19], s63 offen offset:1024 lds
    s_add_u32 m0, s78, 98432
    s_add_u32 s63, s63, 128
    s_and_b32 s63, s63, 1023
    ds_read_b128 v[64:67], v20 offset:0
    ds_read_b128 v[68:71], v20 offset:1024
    ds_read_b128 a[84:87], v16 offset:0
    v_mfma_f32_32x32x16_bf16 v[144:159], a[56:59], v[84:87], v[144:159]
    buffer_load_dwordx4 v2, s[8:11], s63 offen offset:0 lds
    v_mul_f32 v28, v26, v37
    v_mul_f32 v27, 0x3fb8aa3b, v27
    v_exp_f32 v27, v27
    v_mul_f32 v28, 0.15915494, v28
    s_waitcnt lgkmcnt(9)
    v_mfma_f32_32x32x16_bf16 v[128:143], a[64:67], v[88:91], v[128:143]
    ds_read_b128 a[88:91], v13 offset:0
    ds_read_b128 v[72:75], v21 offset:0
    buffer_load_dwordx4 v3, s[8:11], s63 offen offset:1024 lds
    ds_read_b128 v[76:79], v21 offset:1024
    ds_read_b128 a[92:95], v17 offset:0
    v_mfma_f32_32x32x16_bf16 v[144:159], a[64:67], v[92:95], v[144:159]
    v_add_u32 v10, 4294893472, v10
    v_add_u32 v11, 4294893472, v11
    v_add_u32 v12, 4294893472, v12
    v_add_u32 v13, 4294893472, v13
    v_add_u32 v14, 4294893472, v14
    buffer_load_dwordx4 v4, s[8:11], s63 offen offset:2048 lds
    v_add_u32 v15, 4294893472, v15
    s_waitcnt lgkmcnt(9)
    v_mfma_f32_32x32x16_bf16 v[128:143], a[72:75], v[96:99], v[128:143]
    v_add_u32 v16, 4294893472, v16
    v_add_u32 v17, 4294893472, v17
    v_add_u32 v18, 4294893472, v18
    v_add_u32 v19, 4294893472, v19
    v_add_u32 v20, 4294893472, v20
    v_add_u32 v21, 4294893472, v21
    v_mfma_f32_32x32x16_bf16 v[144:159], a[72:75], v[100:103], v[144:159]
    buffer_load_dwordx4 v5, s[8:11], s63 offen offset:3072 lds
    s_add_u32 m0, s79, 114816
    s_nop 0
    s_waitcnt vmcnt(19) lgkmcnt(0)
    s_barrier
    ds_read_b128 a[96:99], v10 offset:0
    ds_read_b128 v[80:83], v18 offset:0
    buffer_load_dwordx4 v6, s[12:15], s63 offen lds
    ds_read_b128 v[84:87], v18 offset:1024
    ds_read_b128 a[100:103], v14 offset:0
    v_mfma_f32_32x32x16_bf16 v[128:143], a[80:83], v[64:67], v[128:143]
    ds_read_b128 a[104:107], v11 offset:0
    ds_read_b128 v[88:91], v19 offset:0
    ds_read_b128 v[92:95], v19 offset:1024
    buffer_load_dwordx4 v6, s[16:19], s63 offen offset:1024 lds
    s_add_u32 m0, s78, 123040
    s_add_u32 s63, s63, 128
    s_and_b32 s63, s63, 1023
    ds_read_b128 a[108:111], v15 offset:0
    v_mfma_f32_32x32x16_bf16 v[144:159], a[80:83], v[68:71], v[144:159]
    ds_read_b128 a[112:115], v12 offset:0
    v_rndne_f32 v29, v28
    v_sub_f32 v28, v28, v29
    buffer_load_dwordx4 v2, s[8:11], s63 offen offset:0 lds
    v_cos_f32 v29, v28
    v_mfma_f32_32x32x16_bf16 v[128:143], a[88:91], v[72:75], v[128:143]
    ds_read_b128 v[96:99], v20 offset:0
    ds_read_b128 v[100:103], v20 offset:1024
    ds_read_b128 a[116:119], v16 offset:0
    v_mfma_f32_32x32x16_bf16 v[144:159], a[88:91], v[76:79], v[144:159]
    buffer_load_dwordx4 v3, s[8:11], s63 offen offset:1024 lds
    v_sin_f32 v30, v28
    s_nop 0
    v_mul_f32 v29, v27, v29
    v_mul_f32 v30, v27, v30
    s_waitcnt lgkmcnt(9)
    v_mfma_f32_32x32x16_bf16 v[128:143], a[96:99], v[80:83], v[128:143]
    ds_read_b128 a[120:123], v13 offset:0
    ds_read_b128 v[64:67], v21 offset:0
    buffer_load_dwordx4 v4, s[8:11], s63 offen offset:2048 lds
    ds_read_b128 v[68:71], v21 offset:1024
    ds_read_b128 a[124:127], v17 offset:0
    v_mfma_f32_32x32x16_bf16 v[144:159], a[96:99], v[84:87], v[144:159]
    v_mul_f32 v31, v36, v36
    v_fma_f32 v31, v37, v37, v31
    v_rcp_f32 v31, v31
    v_add_f32 v32, -1.0, v29
    s_waitcnt lgkmcnt(9)
    buffer_load_dwordx4 v5, s[8:11], s63 offen offset:3072 lds
    s_add_u32 m0, s79, 139424
    s_nop 0
    v_mfma_f32_32x32x16_bf16 v[128:143], a[104:107], v[88:91], v[128:143]
    v_mul_f32 v38, v32, v36
    v_fma_f32 v38, v30, v37, v38
    v_mul_f32 v39, v30, v36
    v_fma_f32 v39, -v32, v37, v39
    v_add_f32 v31, v31, v31
    v_mfma_f32_32x32x16_bf16 v[144:159], a[104:107], v[92:95], v[144:159]
    buffer_load_dwordx4 v6, s[12:15], s63 offen lds
    s_waitcnt vmcnt(18) lgkmcnt(0)
    s_barrier
    ds_read_b128 a[128:131], v10 offset:24608
    ds_read_b128 v[72:75], v18 offset:24608
    ds_read_b128 v[76:79], v18 offset:25632
    buffer_load_dwordx4 v6, s[16:19], s63 offen offset:1024 lds
    s_add_u32 m0, s80, 0
    s_nop 0
    ds_read_b128 a[132:135], v14 offset:24608
    v_mfma_f32_32x32x16_bf16 v[128:143], a[112:115], v[96:99], v[128:143]
    ds_read_b128 a[136:139], v11 offset:24608
    ds_read_b128 v[80:83], v19 offset:24608
    ds_read_b128 v[84:87], v19 offset:25632
    buffer_load_dwordx4 v7, s[20:23], s64 offen offset:0 lds
    ds_read_b128 a[140:143], v15 offset:24608
    v_mfma_f32_32x32x16_bf16 v[144:159], a[112:115], v[100:103], v[144:159]
    ds_read_b128 a[144:147], v12 offset:24608
    v_mul_f32 v38, v38, v31
    v_mul_f32 v39, v39, v31
    v_mov_b32 v36, v29
    v_mov_b32 v37, v30
    v_mfma_f32_32x32x16_bf16 v[128:143], a[120:123], v[64:67], v[128:143]
    ds_read_b128 v[88:91], v20 offset:24608
    ds_read_b128 v[92:95], v20 offset:25632
    buffer_load_dwordx4 v8, s[20:23], s64 offen offset:1024 lds
    ds_read_b128 a[148:151], v16 offset:24608
    v_mfma_f32_32x32x16_bf16 v[144:159], a[120:123], v[68:71], v[144:159]
    v_mul_f32 v26, v37, v37
    v_add_f32 v27, v36, v36
    v_fma_f32 v26, v36, v36, -v26
    v_mul_f32 v27, v27, v37
    v_mul_f32 v28, v27, v27
    s_waitcnt lgkmcnt(9)
    v_mfma_f32_32x32x16_bf16 v[128:143], a[128:131], v[72:75], v[128:143]
    ds_read_b128 a[152:155], v13 offset:24608
    ds_read_b128 v[96:99], v21 offset:24608
    ds_read_b128 v[100:103], v21 offset:25632
    buffer_load_dwordx4 v9, s[20:23], s64 offen offset:2048 lds
    s_add_u32 m0, s80, 12320
    s_nop 0
    ds_read_b128 a[156:159], v17 offset:24608
    v_mfma_f32_32x32x16_bf16 v[144:159], a[128:131], v[76:79], v[144:159]
    v_add_f32 v29, v26, v26
    v_fma_f32 v28, v26, v26, -v28
    v_mul_f32 v29, v29, v27
    v_mul_f32 v34, v29, v29
    v_add_f32 v35, v28, v28
    s_waitcnt lgkmcnt(9)
    v_mfma_f32_32x32x16_bf16 v[128:143], a[136:139], v[80:83], v[128:143]
    v_fma_f32 v34, v28, v28, -v34
    v_mul_f32 v35, v35, v29
    v_mul_f32 v40, v35, v35
    buffer_load_dwordx4 v7, s[24:27], s64 offen offset:0 lds
    v_add_f32 v41, v34, v34
    v_fma_f32 v40, v34, v34, -v40
    v_mfma_f32_32x32x16_bf16 v[144:159], a[136:139], v[84:87], v[144:159]
    s_waitcnt vmcnt(16) lgkmcnt(0)
    s_barrier
    ds_read_b128 a[160:163], v10 offset:49216
    ds_read_b128 v[64:67], v18 offset:49216
    ds_read_b128 v[68:71], v18 offset:50240
    buffer_load_dwordx4 v8, s[24:27], s64 offen offset:1024 lds
    ds_read_b128 a[164:167], v14 offset:49216
    v_mfma_f32_32x32x16_bf16 v[128:143], a[144:147], v[88:91], v[128:143]
    ds_read_b128 a[168:171], v11 offset:49216
    ds_read_b128 v[72:75], v19 offset:49216
    ds_read_b128 v[76:79], v19 offset:50240
    ds_read_b128 a[172:175], v15 offset:49216
    v_mfma_f32_32x32x16_bf16 v[144:159], a[144:147], v[92:95], v[144:159]
    ds_read_b128 a[176:179], v12 offset:49216
    buffer_load_dwordx4 v9, s[24:27], s64 offen offset:2048 lds
    s_add_u32 s64, s64, 176128
    s_cmp_eq_u32 s64, 1409024
    s_cselect_b32 s64, 0, s64
    s_add_u32 m0, s80, 24608
    s_nop 0
    v_mul_f32 v41, v41, v35
    v_mul_f32 v26, v41, v41
    v_add_f32 v27, v40, v40
    v_fma_f32 v26, v40, v40, -v26
    v_mfma_f32_32x32x16_bf16 v[128:143], a[152:155], v[96:99], v[128:143]
    ds_read_b128 v[80:83], v20 offset:49216
    ds_read_b128 v[84:87], v20 offset:50240
    buffer_load_dwordx4 v7, s[20:23], s64 offen offset:0 lds
    ds_read_b128 a[180:183], v16 offset:49216
    v_mfma_f32_32x32x16_bf16 v[144:159], a[152:155], v[100:103], v[144:159]
    v_mul_f32 v27, v27, v41
    v_mul_f32 v28, v27, v27
    v_add_f32 v29, v26, v26
    v_fma_f32 v28, v26, v26, -v28
    v_mul_f32 v29, v29, v27
    s_waitcnt lgkmcnt(9)
    v_mfma_f32_32x32x16_bf16 v[128:143], a[160:163], v[64:67], v[128:143]
    ds_read_b128 a[184:187], v13 offset:49216
    ds_read_b128 v[88:91], v21 offset:49216
    ds_read_b128 v[92:95], v21 offset:50240
    buffer_load_dwordx4 v8, s[20:23], s64 offen offset:1024 lds
    ds_read_b128 a[188:191], v17 offset:49216
    v_mfma_f32_32x32x16_bf16 v[144:159], a[160:163], v[68:71], v[144:159]
    v_add_u32 v10, 73824, v10
    v_add_u32 v11, 73824, v11
    v_add_u32 v12, 73824, v12
    v_add_u32 v13, 73824, v13
    v_add_u32 v14, 73824, v14
    v_add_u32 v15, 73824, v15
    s_waitcnt lgkmcnt(9)
    v_mfma_f32_32x32x16_bf16 v[128:143], a[168:171], v[72:75], v[128:143]
    v_add_u32 v16, 73824, v16
    v_add_u32 v17, 73824, v17
    buffer_load_dwordx4 v9, s[20:23], s64 offen offset:2048 lds
    s_add_u32 m0, s80, 36928
    s_nop 0
    v_add_u32 v18, 73824, v18
    v_add_u32 v19, 73824, v19
    v_add_u32 v20, 73824, v20
    v_add_u32 v21, 73824, v21
    v_mfma_f32_32x32x16_bf16 v[144:159], a[168:171], v[76:79], v[144:159]
    s_waitcnt vmcnt(15) lgkmcnt(0)
    s_barrier
    ds_read_b128 a[192:195], v10 offset:24608
    buffer_load_dwordx4 v7, s[24:27], s64 offen offset:0 lds
    ds_read_b128 v[96:99], v18 offset:24608
    ds_read_b128 v[100:103], v18 offset:25632
    ds_read_b128 a[196:199], v14 offset:24608
    v_mfma_f32_32x32x16_bf16 v[128:143], a[176:179], v[80:83], v[128:143]
    ds_read_b128 a[200:203], v11 offset:24608
    ds_read_b128 v[64:67], v19 offset:24608
    ds_read_b128 v[68:71], v19 offset:25632
    ds_read_b128 a[204:207], v15 offset:24608
    buffer_load_dwordx4 v8, s[24:27], s64 offen offset:1024 lds
    v_mfma_f32_32x32x16_bf16 v[144:159], a[176:179], v[84:87], v[144:159]
    ds_read_b128 a[208:211], v12 offset:24608
    v_mul_f32 v42, v29, v29
    v_add_f32 v43, v28, v28
    v_fma_f32 v42, v28, v28, -v42
    v_mfma_f32_32x32x16_bf16 v[128:143], a[184:187], v[88:91], v[128:143]
    ds_read_b128 v[72:75], v20 offset:24608
    ds_read_b128 v[76:79], v20 offset:25632
    ds_read_b128 a[212:215], v16 offset:24608
    buffer_load_dwordx4 v9, s[24:27], s64 offen offset:2048 lds
    s_add_u32 s64, s64, 176128
    s_cmp_eq_u32 s64, 1409024
    s_cselect_b32 s64, 0, s64
    s_add_u32 m0, s80, 49216
    s_nop 0
    v_mfma_f32_32x32x16_bf16 v[144:159], a[184:187], v[92:95], v[144:159]
    v_mul_f32 v43, v43, v29
    v_mul_f32 v44, v43, v43
    v_add_f32 v45, v42, v42
    v_fma_f32 v44, v42, v42, -v44
    v_mul_f32 v45, v45, v43
    s_waitcnt lgkmcnt(9)
    v_mfma_f32_32x32x16_bf16 v[128:143], a[192:195], v[96:99], v[128:143]
    ds_read_b128 a[216:219], v13 offset:24608
    buffer_load_dwordx4 v7, s[20:23], s64 offen offset:0 lds
    ds_read_b128 v[80:83], v21 offset:24608
    ds_read_b128 v[84:87], v21 offset:25632
    ds_read_b128 a[220:223], v17 offset:24608
    v_mfma_f32_32x32x16_bf16 v[144:159], a[192:195], v[100:103], v[144:159]
    v_lshrrev_b32 v50, 5, v0
    v_cmp_lt_u32 vcc, 31, v1
    s_nop 1
    v_cndmask_b32 v46, 1.0, v40, vcc
    v_cndmask_b32 v47, 0, v41, vcc
    s_waitcnt lgkmcnt(9)
    v_mfma_f32_32x32x16_bf16 v[128:143], a[200:203], v[64:67], v[128:143]
    buffer_load_dwordx4 v8, s[20:23], s64 offen offset:1024 lds
    s_mul_i32 s77, s2, 5504
    s_lshl_b32 s76, s2, 11
    s_bitcmp1_b32 s3, 0
    s_cselect_b64 vcc, -1, 0
    v_cndmask_b32 v26, 1.0, v26, vcc
    v_cndmask_b32 v27, 0, v27, vcc
    v_mfma_f32_32x32x16_bf16 v[144:159], a[200:203], v[68:71], v[144:159]
    s_waitcnt vmcnt(14) lgkmcnt(0)
    s_barrier
    ds_read_b128 a[224:227], v10 offset:49216
    buffer_load_dwordx4 v9, s[20:23], s64 offen offset:2048 lds
    s_add_u32 m0, s80, 61536
    s_nop 0
    ds_read_b128 v[88:91], v18 offset:49216
    ds_read_b128 v[92:95], v18 offset:50240
    ds_read_b128 a[228:231], v14 offset:49216
    v_lshlrev_b32 v48, 5, v0
    v_mfma_f32_32x32x16_bf16 v[128:143], a[208:211], v[72:75], v[128:143]
    ds_read_b128 a[232:235], v11 offset:49216
    ds_read_b128 v[96:99], v19 offset:49216
    buffer_load_dwordx4 v7, s[24:27], s64 offen offset:0 lds
    ds_read_b128 v[100:103], v19 offset:50240
    ds_read_b128 a[236:239], v15 offset:49216
    v_and_b32 v48, 0x1f80, v48
    v_mfma_f32_32x32x16_bf16 v[144:159], a[208:211], v[76:79], v[144:159]
    ds_read_b128 a[240:243], v12 offset:49216
    v_min_u32 v49, 5376, v48
    v_mul_f32 v30, v47, v27
    v_mfma_f32_32x32x16_bf16 v[128:143], a[216:219], v[80:83], v[128:143]
    ds_read_b128 v[64:67], v20 offset:49216
    buffer_load_dwordx4 v8, s[24:27], s64 offen offset:1024 lds
    ds_read_b128 v[68:71], v20 offset:50240
    ds_read_b128 a[244:247], v16 offset:49216
    v_lshrrev_b32 v48, 2, v48
    v_mfma_f32_32x32x16_bf16 v[144:159], a[216:219], v[84:87], v[144:159]
    v_and_b32 v48, 0x780, v48
    v_mul_f32 v31, v47, v26
    v_fma_f32 v30, v46, v26, -v30
    v_fma_f32 v47, v46, v27, v31
    v_mov_b32 v46, v30
    s_waitcnt lgkmcnt(9)
    v_mfma_f32_32x32x16_bf16 v[128:143], a[224:227], v[88:91], v[128:143]
    ds_read_b128 a[248:251], v13 offset:49216
    buffer_load_dwordx4 v9, s[24:27], s64 offen offset:2048 lds
    s_add_u32 s64, s64, 176128
    s_cmp_eq_u32 s64, 1409024
    s_cselect_b32 s64, 0, s64
    s_add_u32 m0, s80, 73824
    s_nop 0
    ds_read_b128 v[72:75], v21 offset:49216
    ds_read_b128 v[76:79], v21 offset:50240
    ds_read_b128 a[252:255], v17 offset:49216
    buffer_load_dword v51, v48, s[36:39], s76 offen
    v_mfma_f32_32x32x16_bf16 v[144:159], a[224:227], v[92:95], v[144:159]
    buffer_load_dword v51, v48, s[40:43], s76 offen
    s_bitcmp1_b32 s3, 1
    s_cselect_b64 vcc, -1, 0
    v_cndmask_b32 v28, 1.0, v28, vcc
    v_cndmask_b32 v29, 0, v29, vcc
    s_waitcnt lgkmcnt(9)
    v_mfma_f32_32x32x16_bf16 v[128:143], a[232:235], v[96:99], v[128:143]
    buffer_load_dword v51, v49, s[44:47], s77 offen
    v_mul_f32 v30, v47, v29
    v_mul_f32 v31, v47, v28
    v_mfma_f32_32x32x16_bf16 v[144:159], a[232:235], v[100:103], v[144:159]
    s_waitcnt vmcnt(15) lgkmcnt(0)
    s_barrier
    ds_read_b64_tr_b16 v[104:105], v22 offset:0
    ds_read_b64_tr_b16 v[106:107], v22 offset:768
    v_mfma_f32_32x32x16_bf16 v[128:143], a[240:243], v[64:67], v[128:143]
    ds_read_b64_tr_b16 v[108:109], v22 offset:32
    ds_read_b64_tr_b16 v[110:111], v22 offset:800
    v_fma_f32 v30, v46, v28, -v30
    v_fma_f32 v47, v46, v29, v31
    v_mov_b32 v46, v30
    v_mfma_f32_32x32x16_bf16 v[144:159], a[240:243], v[68:71], v[144:159]
    buffer_load_dwordx4 v7, s[20:23], s64 offen offset:0 lds
    ds_read_b64_tr_b16 v[112:113], v22 offset:64
    v_lshlrev_b32 v100, 3, v0
    v_add_u32 v100, 147648, v100
    v_and_b32 v101, 31, v1
    v_lshlrev_b32 v101, 3, v101
    v_add_u32 v101, 147648, v101
    v_mfma_f32_32x32x16_bf16 v[128:143], a[248:251], v[72:75], v[128:143]
    ds_read_b64_tr_b16 v[114:115], v22 offset:832
    ds_read_b64_tr_b16 v[116:117], v22 offset:3072
    v_mfma_f32_32x32x16_bf16 v[144:159], a[248:251], v[76:79], v[144:159]
    buffer_load_dwordx4 v8, s[20:23], s64 offen offset:1024 lds
    ds_read_b64_tr_b16 v[118:119], v22 offset:3840
    s_waitcnt lgkmcnt(4)
    v_mfma_f32_32x32x16_bf16 v[160:175], v[104:107], a[0:3], 0
    ds_read_b64_tr_b16 v[120:121], v22 offset:3104
    s_nop 9
    v_pk_fma_f32 v[28:29], v[36:37], v[128:129], v[146:147] op_sel:[1,0,0] op_sel_hi:[1,1,1]
    v_pk_fma_f32 v[26:27], v[36:37], v[144:145], v[130:131] op_sel:[1,0,0] op_sel_hi:[1,1,1] neg_lo:[1,0,0] neg_hi:[1,0,0]
    v_pk_fma_f32 v[30:31], v[36:37], v[128:129], v[26:27] op_sel:[0,0,0] op_sel_hi:[0,1,1]
    v_pk_fma_f32 v[32:33], v[36:37], v[144:145], v[28:29] op_sel:[0,0,0] op_sel_hi:[0,1,1]
    v_pk_fma_f32 v[28:29], v[36:37], v[30:31], v[148:149] op_sel:[1,0,0] op_sel_hi:[1,1,1]
    v_pk_fma_f32 v[26:27], v[36:37], v[32:33], v[132:133] op_sel:[1,0,0] op_sel_hi:[1,1,1] neg_lo:[1,0,0] neg_hi:[1,0,0]
    v_pk_fma_f32 v[30:31], v[36:37], v[30:31], v[26:27] op_sel:[0,0,0] op_sel_hi:[0,1,1]
    v_pk_fma_f32 v[32:33], v[36:37], v[32:33], v[28:29] op_sel:[0,0,0] op_sel_hi:[0,1,1]
    v_pk_fma_f32 v[28:29], v[36:37], v[30:31], v[150:151] op_sel:[1,0,0] op_sel_hi:[1,1,1]
    v_pk_fma_f32 v[26:27], v[36:37], v[32:33], v[134:135] op_sel:[1,0,0] op_sel_hi:[1,1,1] neg_lo:[1,0,0] neg_hi:[1,0,0]
    v_pk_fma_f32 v[30:31], v[36:37], v[30:31], v[26:27] op_sel:[0,0,0] op_sel_hi:[0,1,1]
    v_pk_fma_f32 v[32:33], v[36:37], v[32:33], v[28:29] op_sel:[0,0,0] op_sel_hi:[0,1,1]
    v_pk_fma_f32 v[28:29], v[36:37], v[30:31], v[152:153] op_sel:[1,0,0] op_sel_hi:[1,1,1]
    v_pk_fma_f32 v[26:27], v[36:37], v[32:33], v[136:137] op_sel:[1,0,0] op_sel_hi:[1,1,1] neg_lo:[1,0,0] neg_hi:[1,0,0]
    v_pk_fma_f32 v[30:31], v[36:37], v[30:31], v[26:27] op_sel:[0,0,0] op_sel_hi:[0,1,1]
    v_pk_fma_f32 v[32:33], v[36:37], v[32:33], v[28:29] op_sel:[0,0,0] op_sel_hi:[0,1,1]
    v_pk_fma_f32 v[28:29], v[36:37], v[30:31], v[154:155] op_sel:[1,0,0] op_sel_hi:[1,1,1]
    v_pk_fma_f32 v[26:27], v[36:37], v[32:33], v[138:139] op_sel:[1,0,0] op_sel_hi:[1,1,1] neg_lo:[1,0,0] neg_hi:[1,0,0]
    v_pk_fma_f32 v[30:31], v[36:37], v[30:31], v[26:27] op_sel:[0,0,0] op_sel_hi:[0,1,1]
    v_pk_fma_f32 v[32:33], v[36:37], v[32:33], v[28:29] op_sel:[0,0,0] op_sel_hi:[0,1,1]
    v_pk_fma_f32 v[28:29], v[36:37], v[30:31], v[156:157] op_sel:[1,0,0] op_sel_hi:[1,1,1]
    v_pk_fma_f32 v[26:27], v[36:37], v[32:33], v[140:141] op_sel:[1,0,0] op_sel_hi:[1,1,1] neg_lo:[1,0,0] neg_hi:[1,0,0]
    v_pk_fma_f32 v[30:31], v[36:37], v[30:31], v[26:27] op_sel:[0,0,0] op_sel_hi:[0,1,1]
    v_pk_fma_f32 v[32:33], v[36:37], v[32:33], v[28:29] op_sel:[0,0,0] op_sel_hi:[0,1,1]
    v_pk_fma_f32 v[28:29], v[36:37], v[30:31], v[158:159] op_sel:[1,0,0] op_sel_hi:[1,1,1]
    v_pk_fma_f32 v[26:27], v[36:37], v[32:33], v[142:143] op_sel:[1,0,0] op_sel_hi:[1,1,1] neg_lo:[1,0,0] neg_hi:[1,0,0]
    v_pk_fma_f32 v[30:31], v[36:37], v[30:31], v[26:27] op_sel:[0,0,0] op_sel_hi:[0,1,1]
    v_pk_fma_f32 v[32:33], v[36:37], v[32:33], v[28:29] op_sel:[0,0,0] op_sel_hi:[0,1,1]
    v_mov_b32 v98, v30
    v_mov_b32 v99, v32
    v_mov_b32 v32, v31
    v_pk_fma_f32 v[26:27], v[34:35], v[98:99], v[32:33] op_sel:[1,1,0] op_sel_hi:[1,0,1] neg_lo:[1,0,0]
    v_pk_fma_f32 v[28:29], v[34:35], v[98:99], v[26:27] op_sel:[0,0,0] op_sel_hi:[0,1,1]
    buffer_load_dwordx4 v9, s[20:23], s64 offen offset:2048 lds
    s_add_u32 m0, s80, 86144
    s_nop 0
    ds_write_b64 v100, v[28:29]
    v_mfma_f32_32x32x16_bf16 v[176:191], v[104:107], a[4:7], 0
    ds_read_b64_tr_b16 v[122:123], v22 offset:3872
    v_mfma_f32_32x32x16_bf16 v[192:207], v[108:111], a[0:3], 0
    ds_read_b64_tr_b16 v[124:125], v22 offset:3136
    s_waitcnt lgkmcnt(2)
    s_barrier
    buffer_load_dwordx4 v7, s[24:27], s64 offen offset:0 lds
    ds_read_b64 v[64:65], v101 offset:0
    ds_read_b64 v[66:67], v101 offset:256
    ds_read_b64 v[68:69], v101 offset:512
    ds_read_b64 v[70:71], v101 offset:768
    v_mfma_f32_32x32x16_bf16 v[208:223], v[108:111], a[4:7], 0
    ds_read_b64_tr_b16 v[126:127], v22 offset:3904
    ds_read_b64 v[72:73], v101 offset:1024
    ds_read_b64 v[74:75], v101 offset:1280
    ds_read_b64 v[76:77], v101 offset:1536
    ds_read_b64 v[78:79], v101 offset:1792
    v_mfma_f32_32x32x16_bf16 v[224:239], v[112:115], a[0:3], 0
    ds_read_b64_tr_b16 v[104:105], v22 offset:6144
    buffer_load_dwordx4 v8, s[24:27], s64 offen offset:1024 lds
    v_mov_b32 v82, v24
    v_mov_b32 v83, v24
    v_mov_b32 v48, 0
    v_mov_b32 v49, 0
    v_mfma_f32_32x32x16_bf16 v[240:255], v[112:115], a[4:7], 0
    ds_read_b64_tr_b16 v[106:107], v22 offset:6912
    v_mfma_f32_32x32x16_bf16 v[160:175], v[116:119], a[8:11], v[160:175]
    ds_read_b64_tr_b16 v[108:109], v22 offset:6176
    s_waitcnt lgkmcnt(3)
    v_pk_fma_f32 v[26:27], v[40:41], v[64:65], v[66:67] op_sel:[1,1,0] op_sel_hi:[1,0,1] neg_lo:[1,0,0]
    v_pk_fma_f32 v[66:67], v[40:41], v[64:65], v[26:27] op_sel:[0,0,0] op_sel_hi:[0,1,1]
    v_pk_fma_f32 v[26:27], v[40:41], v[66:67], v[68:69] op_sel:[1,1,0] op_sel_hi:[1,0,1] neg_lo:[1,0,0]
    v_pk_fma_f32 v[68:69], v[40:41], v[66:67], v[26:27] op_sel:[0,0,0] op_sel_hi:[0,1,1]
    v_pk_fma_f32 v[26:27], v[40:41], v[68:69], v[70:71] op_sel:[1,1,0] op_sel_hi:[1,0,1] neg_lo:[1,0,0]
    v_pk_fma_f32 v[70:71], v[40:41], v[68:69], v[26:27] op_sel:[0,0,0] op_sel_hi:[0,1,1]
    v_pk_fma_f32 v[26:27], v[40:41], v[70:71], v[72:73] op_sel:[1,1,0] op_sel_hi:[1,0,1] neg_lo:[1,0,0]
    v_pk_fma_f32 v[72:73], v[40:41], v[70:71], v[26:27] op_sel:[0,0,0] op_sel_hi:[0,1,1]
    v_pk_fma_f32 v[26:27], v[40:41], v[72:73], v[74:75] op_sel:[1,1,0] op_sel_hi:[1,0,1] neg_lo:[1,0,0]
    v_pk_fma_f32 v[74:75], v[40:41], v[72:73], v[26:27] op_sel:[0,0,0] op_sel_hi:[0,1,1]
    v_pk_fma_f32 v[26:27], v[40:41], v[74:75], v[76:77] op_sel:[1,1,0] op_sel_hi:[1,0,1] neg_lo:[1,0,0]
    v_pk_fma_f32 v[76:77], v[40:41], v[74:75], v[26:27] op_sel:[0,0,0] op_sel_hi:[0,1,1]
    v_pk_fma_f32 v[26:27], v[40:41], v[76:77], v[78:79] op_sel:[1,1,0] op_sel_hi:[1,0,1] neg_lo:[1,0,0]
    v_pk_fma_f32 v[80:81], v[40:41], v[76:77], v[26:27] op_sel:[0,0,0] op_sel_hi:[0,1,1]
    buffer_load_dwordx4 v9, s[24:27], s64 offen offset:2048 lds
    s_add_u32 s64, s64, 176128
    s_cmp_eq_u32 s64, 1409024
    s_cselect_b32 s64, 0, s64
    s_lshl_b32 exec_lo, 0xff, s52
    s_mov_b32 exec_hi, 0
    buffer_store_dwordx4 v[80:83], v23, s[28:31], s53 offen sc1
    s_mov_b64 exec, -1
    v_mfma_f32_32x32x16_bf16 v[176:191], v[116:119], a[12:15], v[176:191]
    ds_read_b64_tr_b16 v[110:111], v22 offset:6944
    v_cmp_eq_u32 vcc, 1, v50
    s_nop 1
    v_cndmask_b32 v48, v48, v64, vcc
    v_cndmask_b32 v49, v49, v65, vcc
    v_mfma_f32_32x32x16_bf16 v[192:207], v[120:123], a[8:11], v[192:207]
    ds_read_b64_tr_b16 v[112:113], v22 offset:6208
    v_mfma_f32_32x32x16_bf16 v[208:223], v[120:123], a[12:15], v[208:223]
    ds_read_b64_tr_b16 v[114:115], v22 offset:6976
    v_cmp_eq_u32 vcc, 2, v50
    s_nop 1
    v_cndmask_b32 v48, v48, v66, vcc
    v_cndmask_b32 v49, v49, v67, vcc
    v_mfma_f32_32x32x16_bf16 v[224:239], v[124:127], a[8:11], v[224:239]
    ds_read_b64_tr_b16 v[116:117], v22 offset:9216
    v_cmp_eq_u32 vcc, 3, v50
    s_nop 1
    v_cndmask_b32 v48, v48, v68, vcc
    v_cndmask_b32 v49, v49, v69, vcc
    v_mfma_f32_32x32x16_bf16 v[240:255], v[124:127], a[12:15], v[240:255]
    ds_read_b64_tr_b16 v[118:119], v22 offset:9984
    s_waitcnt lgkmcnt(4)
    v_mfma_f32_32x32x16_bf16 v[160:175], v[104:107], a[16:19], v[160:175]
    ds_read_b64_tr_b16 v[120:121], v22 offset:9248
    v_cmp_eq_u32 vcc, 4, v50
    s_nop 1
    v_cndmask_b32 v48, v48, v70, vcc
    v_cndmask_b32 v49, v49, v71, vcc
    v_mfma_f32_32x32x16_bf16 v[176:191], v[104:107], a[20:23], v[176:191]
    ds_read_b64_tr_b16 v[122:123], v22 offset:10016
    v_mfma_f32_32x32x16_bf16 v[192:207], v[108:111], a[16:19], v[192:207]
    ds_read_b64_tr_b16 v[124:125], v22 offset:9280
    v_cmp_eq_u32 vcc, 5, v50
    s_nop 1
    v_cndmask_b32 v48, v48, v72, vcc
    v_cndmask_b32 v49, v49, v73, vcc
    v_mfma_f32_32x32x16_bf16 v[208:223], v[108:111], a[20:23], v[208:223]
    ds_read_b64_tr_b16 v[126:127], v22 offset:10048
    v_cmp_eq_u32 vcc, 6, v50
    s_nop 1
    v_cndmask_b32 v48, v48, v74, vcc
    v_cndmask_b32 v49, v49, v75, vcc
    s_waitcnt lgkmcnt(4)
    v_mfma_f32_32x32x16_bf16 v[224:239], v[112:115], a[16:19], v[224:239]
    v_add_u32 v22, 24608, v22
    v_mfma_f32_32x32x16_bf16 v[240:255], v[112:115], a[20:23], v[240:255]
    s_waitcnt vmcnt(16) lgkmcnt(0)
    s_barrier
    s_add_u32 m0, s80, 0
    s_nop 0
    buffer_load_dwordx4 v7, s[20:23], s64 offen offset:0 lds
    ds_read_b64_tr_b16 v[104:105], v22 offset:0
    ds_read_b64_tr_b16 v[106:107], v22 offset:768
    v_mfma_f32_32x32x16_bf16 v[160:175], v[116:119], a[24:27], v[160:175]
    ds_read_b64_tr_b16 v[108:109], v22 offset:32
    v_cmp_eq_u32 vcc, 7, v50
    s_nop 1
    v_cndmask_b32 v48, v48, v76, vcc
    v_cndmask_b32 v49, v49, v77, vcc
    v_mfma_f32_32x32x16_bf16 v[176:191], v[116:119], a[28:31], v[176:191]
    ds_read_b64_tr_b16 v[110:111], v22 offset:800
    v_lshrrev_b32 v96, 5, v1
    v_sub_u32 v96, s4, v96
    v_add_u32 v96, 1, v96
    buffer_load_dwordx4 v8, s[20:23], s64 offen offset:1024 lds
    v_mfma_f32_32x32x16_bf16 v[192:207], v[120:123], a[24:27], v[192:207]
    ds_read_b64_tr_b16 v[112:113], v22 offset:64
    v_and_b32 v96, 30, v96
    v_mul_lo_u32 v96, v96, v24
    s_movk_i32 s53, 4096
    v_mfma_f32_32x32x16_bf16 v[208:223], v[120:123], a[28:31], v[208:223]
    ds_read_b64_tr_b16 v[114:115], v22 offset:832
    s_sub_u32 s72, 24608, s78
    v_add_u32 v10, s72, v10
    v_mfma_f32_32x32x16_bf16 v[224:239], v[124:127], a[24:27], v[224:239]
    buffer_load_dwordx4 v9, s[20:23], s64 offen offset:2048 lds
    s_add_u32 m0, s80, 12320
    s_nop 0
    ds_read_b64_tr_b16 v[116:117], v22 offset:3072
    v_add_u32 v11, s72, v11
    v_add_u32 v12, s72, v12
    v_add_u32 v13, s72, v13
    v_mfma_f32_32x32x16_bf16 v[240:255], v[124:127], a[28:31], v[240:255]
    ds_read_b64_tr_b16 v[118:119], v22 offset:3840
    v_mul_f32 v26, v39, v144
    v_mul_f32 v27, v39, v128
    v_fma_f32 v128, v38, v128, -v26
    s_waitcnt lgkmcnt(4)
    v_mfma_f32_32x32x16_bf16 v[160:175], v[104:107], a[32:35], v[160:175]
    ds_read_b64_tr_b16 v[120:121], v22 offset:3104
    buffer_load_dwordx4 v7, s[24:27], s64 offen offset:0 lds
    v_fma_f32 v144, v38, v144, v27
    v_mul_f32 v26, v39, v145
    v_mul_f32 v27, v39, v129
    v_mfma_f32_32x32x16_bf16 v[176:191], v[104:107], a[36:39], v[176:191]
    ds_read_b64_tr_b16 v[122:123], v22 offset:3872
    v_fma_f32 v129, v38, v129, -v26
    v_fma_f32 v145, v38, v145, v27
    v_mul_f32 v26, v39, v146
    v_mfma_f32_32x32x16_bf16 v[192:207], v[108:111], a[32:35], v[192:207]
    ds_read_b64_tr_b16 v[124:125], v22 offset:3136
    v_mul_f32 v27, v39, v130
    v_fma_f32 v130, v38, v130, -v26
    v_fma_f32 v146, v38, v146, v27
    buffer_load_dwordx4 v8, s[24:27], s64 offen offset:1024 lds
    v_mfma_f32_32x32x16_bf16 v[208:223], v[108:111], a[36:39], v[208:223]
    ds_read_b64_tr_b16 v[126:127], v22 offset:3904
    v_mul_f32 v26, v39, v147
    v_mul_f32 v27, v39, v131
    s_waitcnt lgkmcnt(4)
    v_mfma_f32_32x32x16_bf16 v[224:239], v[112:115], a[32:35], v[224:239]
    ds_read_b64_tr_b16 v[104:105], v22 offset:6144
    v_fma_f32 v131, v38, v131, -v26
    v_fma_f32 v147, v38, v147, v27
    v_mul_f32 v26, v39, v148
    v_mfma_f32_32x32x16_bf16 v[240:255], v[112:115], a[36:39], v[240:255]
    buffer_load_dwordx4 v9, s[24:27], s64 offen offset:2048 lds
    s_add_u32 s64, s64, 176128
    s_cmp_eq_u32 s64, 1409024
    s_cselect_b32 s64, 0, s64
    ds_read_b64_tr_b16 v[106:107], v22 offset:6912
    v_mul_f32 v27, v39, v132
    v_fma_f32 v132, v38, v132, -v26
    v_fma_f32 v148, v38, v148, v27
    v_mfma_f32_32x32x16_bf16 v[160:175], v[116:119], a[40:43], v[160:175]
    ds_read_b64_tr_b16 v[108:109], v22 offset:6176
    v_mul_f32 v26, v39, v149
    v_mul_f32 v27, v39, v133
    v_fma_f32 v133, v38, v133, -v26
    v_mfma_f32_32x32x16_bf16 v[176:191], v[116:119], a[44:47], v[176:191]
    ds_read_b64_tr_b16 v[110:111], v22 offset:6944
    v_fma_f32 v149, v38, v149, v27
    v_mul_f32 v26, v39, v150
    v_mul_f32 v27, v39, v134
    s_waitcnt lgkmcnt(4)
    v_mfma_f32_32x32x16_bf16 v[192:207], v[120:123], a[40:43], v[192:207]
    ds_read_b64_tr_b16 v[112:113], v22 offset:6208
    v_fma_f32 v134, v38, v134, -v26
    v_fma_f32 v150, v38, v150, v27
    v_mfma_f32_32x32x16_bf16 v[208:223], v[120:123], a[44:47], v[208:223]
    ds_read_b64_tr_b16 v[114:115], v22 offset:6976
    v_mul_f32 v26, v39, v151
    v_mul_f32 v27, v39, v135
    v_fma_f32 v135, v38, v135, -v26
    v_mfma_f32_32x32x16_bf16 v[224:239], v[124:127], a[40:43], v[224:239]
    ds_read_b64_tr_b16 v[116:117], v22 offset:9216
    v_fma_f32 v151, v38, v151, v27
    v_mul_f32 v26, v39, v152
    v_mul_f32 v27, v39, v136
    v_mfma_f32_32x32x16_bf16 v[240:255], v[124:127], a[44:47], v[240:255]
    ds_read_b64_tr_b16 v[118:119], v22 offset:9984
    v_fma_f32 v136, v38, v136, -v26
    v_fma_f32 v152, v38, v152, v27
    v_mul_f32 v26, v39, v153
    s_waitcnt lgkmcnt(4)
    v_mfma_f32_32x32x16_bf16 v[160:175], v[104:107], a[48:51], v[160:175]
    ds_read_b64_tr_b16 v[120:121], v22 offset:9248
    v_mul_f32 v27, v39, v137
    v_fma_f32 v137, v38, v137, -v26
    v_mfma_f32_32x32x16_bf16 v[176:191], v[104:107], a[52:55], v[176:191]
    ds_read_b64_tr_b16 v[122:123], v22 offset:10016
    v_fma_f32 v153, v38, v153, v27
    v_mul_f32 v26, v39, v154
    v_mul_f32 v27, v39, v138
    v_mfma_f32_32x32x16_bf16 v[192:207], v[108:111], a[48:51], v[192:207]
    ds_read_b64_tr_b16 v[124:125], v22 offset:9280
    v_fma_f32 v138, v38, v138, -v26
    v_fma_f32 v154, v38, v154, v27
    v_mul_f32 v26, v39, v155
    v_mfma_f32_32x32x16_bf16 v[208:223], v[108:111], a[52:55], v[208:223]
    ds_read_b64_tr_b16 v[126:127], v22 offset:10048
    v_mul_f32 v27, v39, v139
    v_fma_f32 v139, v38, v139, -v26
    v_fma_f32 v155, v38, v155, v27
    s_waitcnt lgkmcnt(4)
    v_mfma_f32_32x32x16_bf16 v[224:239], v[112:115], a[48:51], v[224:239]
    v_add_u32 v22, 24608, v22
    v_mul_f32 v26, v39, v156
    v_mul_f32 v27, v39, v140
    v_fma_f32 v140, v38, v140, -v26
    v_mfma_f32_32x32x16_bf16 v[240:255], v[112:115], a[52:55], v[240:255]
    s_waitcnt vmcnt(16) lgkmcnt(0)
    s_barrier
    s_add_u32 m0, s80, 24608
    s_nop 0
    buffer_load_dwordx4 v7, s[20:23], s64 offen offset:0 lds
    ds_read_b64_tr_b16 v[104:105], v22 offset:0
    ds_read_b64_tr_b16 v[106:107], v22 offset:768
    v_mfma_f32_32x32x16_bf16 v[160:175], v[116:119], a[56:59], v[160:175]
    ds_read_b64_tr_b16 v[108:109], v22 offset:32
    v_fma_f32 v156, v38, v156, v27
    v_mul_f32 v26, v39, v157
    v_mfma_f32_32x32x16_bf16 v[176:191], v[116:119], a[60:63], v[176:191]
    ds_read_b64_tr_b16 v[110:111], v22 offset:800
    v_mul_f32 v27, v39, v141
    v_fma_f32 v141, v38, v141, -v26
    v_fma_f32 v157, v38, v157, v27
    buffer_load_dwordx4 v8, s[20:23], s64 offen offset:1024 lds
    v_mfma_f32_32x32x16_bf16 v[192:207], v[120:123], a[56:59], v[192:207]
    ds_read_b64_tr_b16 v[112:113], v22 offset:64
    v_mul_f32 v26, v39, v158
    v_mul_f32 v27, v39, v142
    v_fma_f32 v142, v38, v142, -v26
    v_mfma_f32_32x32x16_bf16 v[208:223], v[120:123], a[60:63], v[208:223]
    ds_read_b64_tr_b16 v[114:115], v22 offset:832
    v_fma_f32 v158, v38, v158, v27
    v_mul_f32 v26, v39, v159
    v_mul_f32 v27, v39, v143
    v_mfma_f32_32x32x16_bf16 v[224:239], v[124:127], a[56:59], v[224:239]
    buffer_load_dwordx4 v9, s[20:23], s64 offen offset:2048 lds
    s_add_u32 m0, s80, 36928
    s_nop 0
    ds_read_b64_tr_b16 v[116:117], v22 offset:3072
    v_fma_f32 v143, v38, v143, -v26
    v_fma_f32 v159, v38, v159, v27
    v_mfma_f32_32x32x16_bf16 v[240:255], v[124:127], a[60:63], v[240:255]
    ds_read_b64_tr_b16 v[118:119], v22 offset:3840
    buffer_load_dwordx4 v[64:67], v23, s[32:35], 0 offen offset:0 sc1
    v_and_b32 v26, 31, v1
    s_waitcnt lgkmcnt(4)
    v_mfma_f32_32x32x16_bf16 v[160:175], v[104:107], a[64:67], v[160:175]
    ds_read_b64_tr_b16 v[120:121], v22 offset:3104
    buffer_load_dwordx4 v[68:71], v23, s[32:35], 0 offen offset:1024 sc1
    v_lshrrev_b32 v27, 5, v1
    v_mfma_f32_32x32x16_bf16 v[176:191], v[104:107], a[68:71], v[176:191]
    ds_read_b64_tr_b16 v[122:123], v22 offset:3872
    buffer_load_dwordx4 v[72:75], v23, s[32:35], 0 offen offset:2048 sc1
    v_lshlrev_b32 v28, 1, v27
    v_mfma_f32_32x32x16_bf16 v[192:207], v[108:111], a[64:67], v[192:207]
    ds_read_b64_tr_b16 v[124:125], v22 offset:3136
    buffer_load_dwordx4 v[76:79], v23, s[32:35], 0 offen offset:3072 sc1
    v_bfe_u32 v29, v1, 1, 2
    v_mfma_f32_32x32x16_bf16 v[208:223], v[108:111], a[68:71], v[208:223]
    ds_read_b64_tr_b16 v[126:127], v22 offset:3904
    buffer_load_dwordx4 v[80:83], v23, s[32:35], s53 offen offset:0 sc1
    s_waitcnt lgkmcnt(4)
    v_mfma_f32_32x32x16_bf16 v[224:239], v[112:115], a[64:67], v[224:239]
    ds_read_b64_tr_b16 v[104:105], v22 offset:6144
    buffer_load_dwordx4 v[84:87], v23, s[32:35], s53 offen offset:1024 sc1
    v_xor_b32 v28, v28, v29
    v_mfma_f32_32x32x16_bf16 v[240:255], v[112:115], a[68:71], v[240:255]
    ds_read_b64_tr_b16 v[106:107], v22 offset:6912
    buffer_load_dwordx4 v[88:91], v23, s[32:35], s53 offen offset:2048 sc1
    v_lshlrev_b32 v28, 4, v28
    v_mfma_f32_32x32x16_bf16 v[160:175], v[116:119], a[72:75], v[160:175]
    ds_read_b64_tr_b16 v[108:109], v22 offset:6176
    buffer_load_dwordx4 v[92:95], v23, s[32:35], s53 offen offset:3072 sc1
    s_add_u32 s72, s79, 149696
    v_mfma_f32_32x32x16_bf16 v[176:191], v[116:119], a[76:79], v[176:191]
    ds_read_b64_tr_b16 v[110:111], v22 offset:6944
    v_lshl_add_u32 v26, v26, 6, v28
    v_add_u32 v14, s72, v26
    v_xor_b32 v26, 16, v26
    s_waitcnt lgkmcnt(4)
    v_mfma_f32_32x32x16_bf16 v[192:207], v[120:123], a[72:75], v[192:207]
    ds_read_b64_tr_b16 v[112:113], v22 offset:6208
    v_add_u32 v15, s72, v26
    v_lshlrev_b32 v27, 3, v27
    buffer_load_dwordx4 v7, s[24:27], s64 offen offset:0 lds
    v_bfe_u32 v28, v1, 2, 2
    v_mfma_f32_32x32x16_bf16 v[208:223], v[120:123], a[76:79], v[208:223]
    ds_read_b64_tr_b16 v[114:115], v22 offset:6976
    v_add_u32 v27, v27, v28
    v_lshlrev_b32 v27, 6, v27
    v_and_b32 v28, 1, v1
    v_mfma_f32_32x32x16_bf16 v[224:239], v[124:127], a[72:75], v[224:239]
    ds_read_b64_tr_b16 v[116:117], v22 offset:9216
    v_lshlrev_b32 v28, 1, v28
    v_bfe_u32 v29, v1, 4, 1
    v_or_b32 v28, v28, v29
    v_mfma_f32_32x32x16_bf16 v[240:255], v[124:127], a[76:79], v[240:255]
    buffer_load_dwordx4 v8, s[24:27], s64 offen offset:1024 lds
    ds_read_b64_tr_b16 v[118:119], v22 offset:9984
    v_bfe_u32 v29, v1, 3, 1
    v_xor_b32 v28, v28, v29
    s_waitcnt lgkmcnt(4)
    v_mfma_f32_32x32x16_bf16 v[160:175], v[104:107], a[80:83], v[160:175]
    ds_read_b64_tr_b16 v[120:121], v22 offset:9248
    v_lshl_add_u32 v27, v28, 4, v27
    v_bfe_u32 v28, v1, 1, 1
    v_lshl_add_u32 v27, v28, 3, v27
    v_mfma_f32_32x32x16_bf16 v[176:191], v[104:107], a[84:87], v[176:191]
    ds_read_b64_tr_b16 v[122:123], v22 offset:10016
    v_add_u32 v16, s72, v27
    v_xor_b32 v27, 32, v27
    buffer_load_dwordx4 v9, s[24:27], s64 offen offset:2048 lds
    s_add_u32 s64, s64, 176128
    s_cmp_eq_u32 s64, 1409024
    s_cselect_b32 s64, 0, s64
    v_add_u32 v17, s72, v27
    v_mfma_f32_32x32x16_bf16 v[192:207], v[108:111], a[80:83], v[192:207]
    ds_read_b64_tr_b16 v[124:125], v22 offset:9280
    s_lshl2_add_u32 s75, s65, s54
    s_lshl_b32 s75, s75, 7
    s_and_b32 s74, s75, 0xfffffdff
    v_mfma_f32_32x32x16_bf16 v[208:223], v[108:111], a[84:87], v[208:223]
    ds_read_b64_tr_b16 v[126:127], v22 offset:10048
    s_add_u32 s75, s75, 12713984
    s_add_u32 s68, s74, 12976128
    s_waitcnt lgkmcnt(4)
    v_mfma_f32_32x32x16_bf16 v[224:239], v[112:115], a[80:83], v[224:239]
    v_add_u32 v22, 24608, v22
    s_add_u32 s74, s74, 12582912
    s_lshl2_add_u32 s82, s65, s7
    s_lshl_b32 s82, s82, 7
    v_mfma_f32_32x32x16_bf16 v[240:255], v[112:115], a[84:87], v[240:255]
    s_waitcnt vmcnt(21) lgkmcnt(0)
    s_barrier
    s_add_u32 m0, s80, 49216
    s_nop 0
    buffer_load_dwordx4 v7, s[20:23], s64 offen offset:0 lds
    ds_read_b64_tr_b16 v[104:105], v22 offset:0
    ds_read_b64_tr_b16 v[106:107], v22 offset:768
    v_mfma_f32_32x32x16_bf16 v[160:175], v[116:119], a[88:91], v[160:175]
    ds_read_b64_tr_b16 v[108:109], v22 offset:32
    s_add_u32 s82, s82, 12845056
    s_load_dword s16, s[28:29], s74 glc
    s_load_dword s17, s[28:29], s75 glc
    v_mfma_f32_32x32x16_bf16 v[176:191], v[116:119], a[92:95], v[176:191]
    ds_read_b64_tr_b16 v[110:111], v22 offset:800
    s_load_dword s18, s[28:29], s82 glc
    s_load_dword s19, s[28:29], s68 glc
    s_lshl_b32 s76, s5, 11
    buffer_load_dwordx4 v8, s[20:23], s64 offen offset:1024 lds
    v_mfma_f32_32x32x16_bf16 v[192:207], v[120:123], a[88:91], v[192:207]
    ds_read_b64_tr_b16 v[112:113], v22 offset:64
    s_add_u32 s76, s76, s67
    s_add_u32 s76, s76, 98304
    s_add_u32 s77, s76, 32768
    v_mfma_f32_32x32x16_bf16 v[208:223], v[120:123], a[92:95], v[208:223]
    ds_read_b64_tr_b16 v[114:115], v22 offset:832
    s_waitcnt vmcnt(5)
    s_mov_b32 s81, 0
L_chkagg:
    v_add_u32 v26, v66, v67
    v_add3_u32 v26, v26, v70, v71
    v_add3_u32 v26, v26, v74, v75
    v_add3_u32 v26, v26, v78, v79
    v_add3_u32 v26, v26, v82, v83
    v_add3_u32 v26, v26, v86, v87
    v_add3_u32 v26, v26, v90, v91
    v_add3_u32 v26, v26, v94, v95
    v_cmp_ne_u32 vcc, v96, v26
    s_add_u32 s81, s81, 1
    s_cbranch_vccz L_aggok
    s_cmp_gt_u32 s81, 200000
    s_cbranch_scc1 L_aggok
    s_sleep 8
    buffer_load_dwordx4 v[64:67], v23, s[32:35], 0 offen offset:0 sc1
    buffer_load_dwordx4 v[68:71], v23, s[32:35], 0 offen offset:1024 sc1
    buffer_load_dwordx4 v[72:75], v23, s[32:35], 0 offen offset:2048 sc1
    buffer_load_dwordx4 v[76:79], v23, s[32:35], 0 offen offset:3072 sc1
    buffer_load_dwordx4 v[80:83], v23, s[32:35], s53 offen offset:0 sc1
    buffer_load_dwordx4 v[84:87], v23, s[32:35], s53 offen offset:1024 sc1
    buffer_load_dwordx4 v[88:91], v23, s[32:35], s53 offen offset:2048 sc1
    buffer_load_dwordx4 v[92:95], v23, s[32:35], s53 offen offset:3072 sc1
    s_waitcnt vmcnt(0)
    s_branch L_chkagg
L_aggok:
    buffer_load_dwordx4 v9, s[20:23], s64 offen offset:2048 lds
    s_add_u32 m0, s80, 61536
    s_nop 0
    v_pk_fma_f32 v[26:27], v[44:45], v[92:93], v[88:89] op_sel:[1,1,0] op_sel_hi:[1,0,1] neg_lo:[1,0,0]
    v_pk_fma_f32 v[28:29], v[44:45], v[92:93], v[26:27] op_sel:[0,0,0] op_sel_hi:[0,1,1]
    v_pk_fma_f32 v[26:27], v[44:45], v[28:29], v[84:85] op_sel:[1,1,0] op_sel_hi:[1,0,1] neg_lo:[1,0,0]
    v_pk_fma_f32 v[28:29], v[44:45], v[28:29], v[26:27] op_sel:[0,0,0] op_sel_hi:[0,1,1]
    v_pk_fma_f32 v[26:27], v[44:45], v[28:29], v[80:81] op_sel:[1,1,0] op_sel_hi:[1,0,1] neg_lo:[1,0,0]
    v_pk_fma_f32 v[28:29], v[44:45], v[28:29], v[26:27] op_sel:[0,0,0] op_sel_hi:[0,1,1]
    v_pk_fma_f32 v[26:27], v[44:45], v[28:29], v[76:77] op_sel:[1,1,0] op_sel_hi:[1,0,1] neg_lo:[1,0,0]
    v_pk_fma_f32 v[28:29], v[44:45], v[28:29], v[26:27] op_sel:[0,0,0] op_sel_hi:[0,1,1]
    v_pk_fma_f32 v[26:27], v[44:45], v[28:29], v[72:73] op_sel:[1,1,0] op_sel_hi:[1,0,1] neg_lo:[1,0,0]
    v_pk_fma_f32 v[28:29], v[44:45], v[28:29], v[26:27] op_sel:[0,0,0] op_sel_hi:[0,1,1]
    v_pk_fma_f32 v[26:27], v[44:45], v[28:29], v[68:69] op_sel:[1,1,0] op_sel_hi:[1,0,1] neg_lo:[1,0,0]
    v_pk_fma_f32 v[28:29], v[44:45], v[28:29], v[26:27] op_sel:[0,0,0] op_sel_hi:[0,1,1]
    v_pk_fma_f32 v[26:27], v[44:45], v[28:29], v[64:65] op_sel:[1,1,0] op_sel_hi:[1,0,1] neg_lo:[1,0,0]
    v_pk_fma_f32 v[28:29], v[44:45], v[28:29], v[26:27] op_sel:[0,0,0] op_sel_hi:[0,1,1]
    v_mov_b32 v30, v28
    v_mov_b32 v31, v29
    s_nop 1
    v_permlane32_swap_b32 v28, v30
    v_permlane32_swap_b32 v29, v31
    s_nop 1
    v_pk_fma_f32 v[26:27], v[42:43], v[30:31], v[28:29] op_sel:[1,1,0] op_sel_hi:[1,0,1] neg_lo:[1,0,0]
    v_pk_fma_f32 v[28:29], v[42:43], v[30:31], v[26:27] op_sel:[0,0,0] op_sel_hi:[0,1,1]
    v_pk_fma_f32 v[26:27], v[46:47], v[28:29], v[48:49] op_sel:[1,1,0] op_sel_hi:[1,0,1] neg_lo:[1,0,0]
    v_pk_fma_f32 v[48:49], v[46:47], v[28:29], v[26:27] op_sel:[0,0,0] op_sel_hi:[0,1,1]
    v_pk_fma_f32 v[26:27], v[34:35], v[48:49], v[98:99] op_sel:[1,1,0] op_sel_hi:[1,0,1] neg_lo:[1,0,0]
    v_pk_fma_f32 v[98:99], v[34:35], v[48:49], v[26:27] op_sel:[0,0,0] op_sel_hi:[0,1,1]
    v_mov_b32 v26, v49
    v_mov_b32 v49, v98
    v_mov_b32 v98, v26
    v_pk_mul_f32 v[26:27], v[38:39], v[98:99] op_sel:[1,0] op_sel_hi:[1,1] neg_lo:[1,0] neg_hi:[1,0]
    v_pk_mul_f32 v[28:29], v[38:39], v[48:49] op_sel:[1,0] op_sel_hi:[1,1]
    v_pk_fma_f32 v[48:49], v[38:39], v[48:49], v[26:27] op_sel:[0,0,0] op_sel_hi:[0,1,1]
    v_pk_fma_f32 v[98:99], v[38:39], v[98:99], v[28:29] op_sel:[0,0,0] op_sel_hi:[0,1,1]
    v_pk_fma_f32 v[144:145], v[36:37], v[48:49], v[144:145] op_sel:[1,0,0] op_sel_hi:[1,1,1]
    v_pk_fma_f32 v[128:129], v[36:37], v[98:99], v[128:129] op_sel:[1,0,0] op_sel_hi:[1,1,1] neg_lo:[1,0,0] neg_hi:[1,0,0]
    v_pk_fma_f32 v[128:129], v[36:37], v[48:49], v[128:129] op_sel:[0,0,0] op_sel_hi:[0,1,1]
    v_pk_fma_f32 v[144:145], v[36:37], v[98:99], v[144:145] op_sel:[0,0,0] op_sel_hi:[0,1,1]
    v_pk_fma_f32 v[146:147], v[36:37], v[128:129], v[146:147] op_sel:[1,0,0] op_sel_hi:[1,1,1]
    v_pk_fma_f32 v[130:131], v[36:37], v[144:145], v[130:131] op_sel:[1,0,0] op_sel_hi:[1,1,1] neg_lo:[1,0,0] neg_hi:[1,0,0]
    v_pk_fma_f32 v[130:131], v[36:37], v[128:129], v[130:131] op_sel:[0,0,0] op_sel_hi:[0,1,1]
    v_pk_fma_f32 v[146:147], v[36:37], v[144:145], v[146:147] op_sel:[0,0,0] op_sel_hi:[0,1,1]
    v_pk_fma_f32 v[148:149], v[36:37], v[130:131], v[148:149] op_sel:[1,0,0] op_sel_hi:[1,1,1]
    v_pk_fma_f32 v[132:133], v[36:37], v[146:147], v[132:133] op_sel:[1,0,0] op_sel_hi:[1,1,1] neg_lo:[1,0,0] neg_hi:[1,0,0]
    v_pk_fma_f32 v[132:133], v[36:37], v[130:131], v[132:133] op_sel:[0,0,0] op_sel_hi:[0,1,1]
    v_pk_fma_f32 v[148:149], v[36:37], v[146:147], v[148:149] op_sel:[0,0,0] op_sel_hi:[0,1,1]
    v_pk_fma_f32 v[150:151], v[36:37], v[132:133], v[150:151] op_sel:[1,0,0] op_sel_hi:[1,1,1]
    v_pk_fma_f32 v[134:135], v[36:37], v[148:149], v[134:135] op_sel:[1,0,0] op_sel_hi:[1,1,1] neg_lo:[1,0,0] neg_hi:[1,0,0]
    v_pk_fma_f32 v[134:135], v[36:37], v[132:133], v[134:135] op_sel:[0,0,0] op_sel_hi:[0,1,1]
    v_pk_fma_f32 v[150:151], v[36:37], v[148:149], v[150:151] op_sel:[0,0,0] op_sel_hi:[0,1,1]
    v_pk_fma_f32 v[152:153], v[36:37], v[134:135], v[152:153] op_sel:[1,0,0] op_sel_hi:[1,1,1]
    v_pk_fma_f32 v[136:137], v[36:37], v[150:151], v[136:137] op_sel:[1,0,0] op_sel_hi:[1,1,1] neg_lo:[1,0,0] neg_hi:[1,0,0]
    v_pk_fma_f32 v[136:137], v[36:37], v[134:135], v[136:137] op_sel:[0,0,0] op_sel_hi:[0,1,1]
    v_pk_fma_f32 v[152:153], v[36:37], v[150:151], v[152:153] op_sel:[0,0,0] op_sel_hi:[0,1,1]
    v_pk_fma_f32 v[154:155], v[36:37], v[136:137], v[154:155] op_sel:[1,0,0] op_sel_hi:[1,1,1]
    v_pk_fma_f32 v[138:139], v[36:37], v[152:153], v[138:139] op_sel:[1,0,0] op_sel_hi:[1,1,1] neg_lo:[1,0,0] neg_hi:[1,0,0]
    v_pk_fma_f32 v[138:139], v[36:37], v[136:137], v[138:139] op_sel:[0,0,0] op_sel_hi:[0,1,1]
    v_pk_fma_f32 v[154:155], v[36:37], v[152:153], v[154:155] op_sel:[0,0,0] op_sel_hi:[0,1,1]
    v_pk_fma_f32 v[156:157], v[36:37], v[138:139], v[156:157] op_sel:[1,0,0] op_sel_hi:[1,1,1]
    v_pk_fma_f32 v[140:141], v[36:37], v[154:155], v[140:141] op_sel:[1,0,0] op_sel_hi:[1,1,1] neg_lo:[1,0,0] neg_hi:[1,0,0]
    v_pk_fma_f32 v[140:141], v[36:37], v[138:139], v[140:141] op_sel:[0,0,0] op_sel_hi:[0,1,1]
    v_pk_fma_f32 v[156:157], v[36:37], v[154:155], v[156:157] op_sel:[0,0,0] op_sel_hi:[0,1,1]
    v_pk_fma_f32 v[158:159], v[36:37], v[140:141], v[158:159] op_sel:[1,0,0] op_sel_hi:[1,1,1]
    v_pk_fma_f32 v[142:143], v[36:37], v[156:157], v[142:143] op_sel:[1,0,0] op_sel_hi:[1,1,1] neg_lo:[1,0,0] neg_hi:[1,0,0]
    v_pk_fma_f32 v[142:143], v[36:37], v[140:141], v[142:143] op_sel:[0,0,0] op_sel_hi:[0,1,1]
    v_pk_fma_f32 v[158:159], v[36:37], v[156:157], v[158:159] op_sel:[0,0,0] op_sel_hi:[0,1,1]
    buffer_load_dwordx4 v7, s[24:27], s64 offen offset:0 lds
    v_mfma_f32_32x32x16_bf16 v[224:239], v[124:127], a[88:91], v[224:239]
    ds_read_b64_tr_b16 v[116:117], v22 offset:3072
    v_cvt_pk_bf16_f32 v64, v128, v129
    v_cvt_pk_bf16_f32 v65, v130, v131
    v_cvt_pk_bf16_f32 v66, v132, v133
    v_cvt_pk_bf16_f32 v67, v134, v135
    v_mfma_f32_32x32x16_bf16 v[240:255], v[124:127], a[92:95], v[240:255]
    ds_read_b64_tr_b16 v[118:119], v22 offset:3840
    ds_write_b128 v14, v[64:67]
    v_cvt_pk_bf16_f32 v68, v136, v137
    v_cvt_pk_bf16_f32 v69, v138, v139
    buffer_load_dwordx4 v8, s[24:27], s64 offen offset:1024 lds
    s_waitcnt lgkmcnt(5)
    v_mfma_f32_32x32x16_bf16 v[160:175], v[104:107], a[96:99], v[160:175]
    ds_read_b64_tr_b16 v[120:121], v22 offset:3104
    v_cvt_pk_bf16_f32 v70, v140, v141
    v_cvt_pk_bf16_f32 v71, v142, v143
    ds_write_b128 v15, v[68:71]
    v_mfma_f32_32x32x16_bf16 v[176:191], v[104:107], a[100:103], v[176:191]
    ds_read_b64_tr_b16 v[122:123], v22 offset:3872
    ds_read_b64_tr_b16 v[80:81], v16 offset:0
    ds_read_b64_tr_b16 v[82:83], v17 offset:256
    ds_read_b64_tr_b16 v[84:85], v16 offset:1024
    buffer_load_dwordx4 v9, s[24:27], s64 offen offset:2048 lds
    s_add_u32 s64, s64, 176128
    s_cmp_eq_u32 s64, 1409024
    s_cselect_b32 s64, 0, s64
    ds_read_b64_tr_b16 v[86:87], v17 offset:1280
    v_mfma_f32_32x32x16_bf16 v[192:207], v[108:111], a[96:99], v[192:207]
    ds_read_b64_tr_b16 v[124:125], v22 offset:3136
    v_cvt_pk_bf16_f32 v72, -v144, -v145
    v_cvt_pk_bf16_f32 v73, -v146, -v147
    v_cvt_pk_bf16_f32 v74, -v148, -v149
    v_cvt_pk_bf16_f32 v75, -v150, -v151
    v_mfma_f32_32x32x16_bf16 v[208:223], v[108:111], a[100:103], v[208:223]
    ds_read_b64_tr_b16 v[126:127], v22 offset:3904
    ds_write_b128 v14, v[72:75]
    v_cvt_pk_bf16_f32 v76, -v152, -v153
    v_cvt_pk_bf16_f32 v77, -v154, -v155
    s_waitcnt lgkmcnt(11)
    v_mfma_f32_32x32x16_bf16 v[224:239], v[112:115], a[96:99], v[224:239]
    ds_read_b64_tr_b16 v[104:105], v22 offset:6144
    v_cvt_pk_bf16_f32 v78, -v156, -v157
    v_cvt_pk_bf16_f32 v79, -v158, -v159
    ds_write_b128 v15, v[76:79]
    v_mfma_f32_32x32x16_bf16 v[240:255], v[112:115], a[100:103], v[240:255]
    ds_read_b64_tr_b16 v[106:107], v22 offset:6912
    ds_read_b64_tr_b16 v[88:89], v16 offset:0
    ds_read_b64_tr_b16 v[90:91], v17 offset:256
    ds_read_b64_tr_b16 v[92:93], v16 offset:1024
    ds_read_b64_tr_b16 v[94:95], v17 offset:1280
    v_mfma_f32_32x32x16_bf16 v[160:175], v[116:119], a[104:107], v[160:175]
    ds_read_b64_tr_b16 v[108:109], v22 offset:6176
    v_mfma_f32_32x32x16_bf16 v[176:191], v[116:119], a[108:111], v[176:191]
    ds_read_b64_tr_b16 v[110:111], v22 offset:6944
    s_waitcnt lgkmcnt(14)
    s_waitcnt lgkmcnt(10)
    v_mfma_f32_32x32x16_bf16 v[192:207], v[120:123], a[104:107], v[192:207]
    ds_read_b64_tr_b16 v[112:113], v22 offset:6208
    buffer_store_dwordx4 v[80:83], v23, s[28:31], s76 offen offset:0 sc1
    v_mfma_f32_32x32x16_bf16 v[208:223], v[120:123], a[108:111], v[208:223]
    ds_read_b64_tr_b16 v[114:115], v22 offset:6976
    v_mfma_f32_32x32x16_bf16 v[224:239], v[124:127], a[104:107], v[224:239]
    ds_read_b64_tr_b16 v[116:117], v22 offset:9216
    buffer_store_dwordx4 v[84:87], v23, s[28:31], s76 offen offset:1024 sc1
    v_mfma_f32_32x32x16_bf16 v[240:255], v[124:127], a[108:111], v[240:255]
    ds_read_b64_tr_b16 v[118:119], v22 offset:9984
    s_waitcnt lgkmcnt(8)
    s_waitcnt lgkmcnt(4)
    v_mfma_f32_32x32x16_bf16 v[160:175], v[104:107], a[112:115], v[160:175]
    ds_read_b64_tr_b16 v[120:121], v22 offset:9248
    buffer_store_dwordx4 v[88:91], v23, s[28:31], s77 offen offset:0 sc1
    v_mfma_f32_32x32x16_bf16 v[176:191], v[104:107], a[116:119], v[176:191]
    ds_read_b64_tr_b16 v[122:123], v22 offset:10016
    v_mfma_f32_32x32x16_bf16 v[192:207], v[108:111], a[112:115], v[192:207]
    ds_read_b64_tr_b16 v[124:125], v22 offset:9280
    buffer_store_dwordx4 v[92:95], v23, s[28:31], s77 offen offset:1024 sc1
    v_mfma_f32_32x32x16_bf16 v[208:223], v[108:111], a[116:119], v[208:223]
    ds_read_b64_tr_b16 v[126:127], v22 offset:10048
    s_waitcnt lgkmcnt(4)
    v_mfma_f32_32x32x16_bf16 v[224:239], v[112:115], a[112:115], v[224:239]
    v_add_u32 v22, 4294893472, v22
    v_mfma_f32_32x32x16_bf16 v[240:255], v[112:115], a[116:119], v[240:255]
    s_waitcnt lgkmcnt(0)
    s_barrier
    s_add_u32 m0, s80, 73824
    s_nop 0
    buffer_load_dwordx4 v7, s[20:23], s64 offen offset:0 lds
    ds_read_b64_tr_b16 v[104:105], v22 offset:0
    ds_read_b64_tr_b16 v[106:107], v22 offset:768
    v_mfma_f32_32x32x16_bf16 v[160:175], v[116:119], a[120:123], v[160:175]
    ds_read_b64_tr_b16 v[108:109], v22 offset:32
    v_mfma_f32_32x32x16_bf16 v[176:191], v[116:119], a[124:127], v[176:191]
    ds_read_b64_tr_b16 v[110:111], v22 offset:800
    s_mul_i32 s59, s54, 24576
    v_mfma_f32_32x32x16_bf16 v[192:207], v[120:123], a[120:123], v[192:207]
    buffer_load_dwordx4 v8, s[20:23], s64 offen offset:1024 lds
    ds_read_b64_tr_b16 v[112:113], v22 offset:64
    s_add_u32 s72, s67, s59
    v_add_u32 v2, s72, v23
    v_mfma_f32_32x32x16_bf16 v[208:223], v[120:123], a[124:127], v[208:223]
    ds_read_b64_tr_b16 v[114:115], v22 offset:832
    s_lshl_b32 s73, s54, 13
    s_add_u32 s72, s67, s73
    v_mfma_f32_32x32x16_bf16 v[224:239], v[124:127], a[120:123], v[224:239]
    ds_read_b64_tr_b16 v[116:117], v22 offset:3072
    v_add_u32 v3, s72, v23
    v_mfma_f32_32x32x16_bf16 v[240:255], v[124:127], a[124:127], v[240:255]
    buffer_load_dwordx4 v9, s[20:23], s64 offen offset:2048 lds
    s_add_u32 m0, s80, 86144
    s_nop 0
    ds_read_b64_tr_b16 v[118:119], v22 offset:3840
    v_bfe_u32 v26, v1, 2, 1
    v_lshlrev_b32 v26, 4, v26
    s_waitcnt lgkmcnt(4)
    v_mfma_f32_32x32x16_bf16 v[160:175], v[104:107], a[128:131], v[160:175]
    ds_read_b64_tr_b16 v[120:121], v22 offset:3104
    v_and_b32 v27, 1, v1
    v_mfma_f32_32x32x16_bf16 v[176:191], v[104:107], a[132:135], v[176:191]
    ds_read_b64_tr_b16 v[122:123], v22 offset:3872
    buffer_load_dwordx4 v7, s[24:27], s64 offen offset:0 lds
    v_lshl_add_u32 v26, v27, 3, v26
    v_mfma_f32_32x32x16_bf16 v[192:207], v[108:111], a[128:131], v[192:207]
    ds_read_b64_tr_b16 v[124:125], v22 offset:3136
    v_bfe_u32 v27, v1, 1, 1
    v_add_u32 v26, v26, v27
    v_mfma_f32_32x32x16_bf16 v[208:223], v[108:111], a[132:135], v[208:223]
    ds_read_b64_tr_b16 v[126:127], v22 offset:3904
    v_bfe_u32 v27, v1, 3, 2
    s_waitcnt lgkmcnt(4)
    v_mfma_f32_32x32x16_bf16 v[224:239], v[112:115], a[128:131], v[224:239]
    buffer_load_dwordx4 v8, s[24:27], s64 offen offset:1024 lds
    ds_read_b64_tr_b16 v[104:105], v22 offset:6144
    v_lshl_add_u32 v26, v27, 1, v26
    v_and_b32 v27, 32, v1
    v_mfma_f32_32x32x16_bf16 v[240:255], v[112:115], a[132:135], v[240:255]
    ds_read_b64_tr_b16 v[106:107], v22 offset:6912
    v_add_u32 v26, v26, v27
    v_mfma_f32_32x32x16_bf16 v[160:175], v[116:119], a[136:139], v[160:175]
    ds_read_b64_tr_b16 v[108:109], v22 offset:6176
    s_lshl_b32 s72, s65, 5
    v_xor_b32 v26, s72, v26
    v_mfma_f32_32x32x16_bf16 v[176:191], v[116:119], a[140:143], v[176:191]
    buffer_load_dwordx4 v9, s[24:27], s64 offen offset:2048 lds
    s_add_u32 s64, s64, 176128
    s_cmp_eq_u32 s64, 1409024
    s_cselect_b32 s64, 0, s64
    s_sub_u32 s44, s44, 4096
    s_subb_u32 s45, s45, 0
    s_mov_b32 s46, 1413120
    ds_read_b64_tr_b16 v[110:111], v22 offset:6944
    s_mov_b32 s12, s44
    s_mov_b32 s13, s45
    s_cmp_eq_u32 s3, 3
    s_cselect_b32 s14, 0, s46
    v_lshlrev_b32 v21, 3, v26
    s_add_u32 m0, s78, 98432
    s_mov_b32 s70, 0
    s_waitcnt lgkmcnt(4)
    v_mfma_f32_32x32x16_bf16 v[192:207], v[120:123], a[136:139], v[192:207]
    buffer_load_dwordx4 v52, s[36:39], s70 offen offset:0 lds
    ds_read_b64_tr_b16 v[112:113], v22 offset:6208
    s_mov_b32 s76, 11534336
    v_mfma_f32_32x32x16_bf16 v[208:223], v[120:123], a[140:143], v[208:223]
    ds_read_b64_tr_b16 v[114:115], v22 offset:6976
    buffer_load_dwordx2 v[4:5], v21, s[28:31], s76 offen sc1
    v_and_b32 v32, 7, v1
    v_lshlrev_b32 v32, 3, v32
    s_lshl_b32 s77, s57, 1
    v_mfma_f32_32x32x16_bf16 v[224:239], v[124:127], a[136:139], v[224:239]
    v_add_u32 v32, s77, v32
    ds_read_b64_tr_b16 v[116:117], v22 offset:9216
    v_mfma_f32_32x32x16_bf16 v[240:255], v[124:127], a[140:143], v[240:255]
    ds_read_b64_tr_b16 v[118:119], v22 offset:9984
    s_waitcnt lgkmcnt(4)
    global_load_dwordx2 v[36:37], v32, s[60:61]
    v_bfe_u32 v33, v1, 3, 2
    v_lshl_add_u32 v32, v33, 11, v32
    v_lshrrev_b32 v33, 5, v1
    v_mfma_f32_32x32x16_bf16 v[160:175], v[104:107], a[144:147], v[160:175]
    v_lshl_add_u32 v32, v33, 14, v32
    s_lshl_b32 s77, s65, 15
    ds_read_b64_tr_b16 v[120:121], v22 offset:9248
    v_mfma_f32_32x32x16_bf16 v[176:191], v[104:107], a[148:151], v[176:191]
    buffer_load_dwordx2 v[42:43], v32, s[8:11], s77 offen offset:0
    ds_read_b64_tr_b16 v[122:123], v22 offset:10016
    v_mfma_f32_32x32x16_bf16 v[192:207], v[108:111], a[144:147], v[192:207]
    ds_read_b64_tr_b16 v[124:125], v22 offset:9280
    v_mfma_f32_32x32x16_bf16 v[208:223], v[108:111], a[148:151], v[208:223]
    buffer_load_dwordx2 v[46:47], v32, s[8:11], s77 offen offset:1024
    s_add_u32 s77, s77, 8192
    ds_read_b64_tr_b16 v[126:127], v22 offset:10048
    s_waitcnt lgkmcnt(4)
    v_mfma_f32_32x32x16_bf16 v[224:239], v[112:115], a[144:147], v[224:239]
    v_add_u32 v22, 24608, v22
    v_mfma_f32_32x32x16_bf16 v[240:255], v[112:115], a[148:151], v[240:255]
    s_lshl_b32 s69, s7, 2
    s_add_u32 s69, s69, s75
    s_waitcnt vmcnt(11)
    s_mov_b64 exec, 1
    buffer_store_dword v24, v23, s[28:31], s69 offen sc1
    s_mov_b64 exec, -1
    buffer_load_dwordx2 v[44:45], v32, s[8:11], s77 offen offset:0
    s_waitcnt vmcnt(7) lgkmcnt(0)
    s_barrier
    ds_read_b64_tr_b16 v[104:105], v22 offset:0
    ds_read_b64_tr_b16 v[106:107], v22 offset:768
    buffer_load_dwordx2 v[48:49], v32, s[8:11], s77 offen offset:1024
    v_mfma_f32_32x32x16_bf16 v[160:175], v[116:119], a[152:155], v[160:175]
    ds_read_b64_tr_b16 v[108:109], v22 offset:3072
    v_mfma_f32_32x32x16_bf16 v[176:191], v[116:119], a[156:159], v[176:191]
    buffer_load_dwordx4 v53, s[36:39], s70 offen offset:1024 lds
    ds_read_b64_tr_b16 v[110:111], v22 offset:3840
    v_mfma_f32_32x32x16_bf16 v[192:207], v[120:123], a[152:155], v[192:207]
    ds_read_b64_tr_b16 v[112:113], v22 offset:6144
    v_mfma_f32_32x32x16_bf16 v[208:223], v[120:123], a[156:159], v[208:223]
    buffer_load_dwordx4 v54, s[36:39], s70 offen offset:2048 lds
    ds_read_b64_tr_b16 v[114:115], v22 offset:6912
    v_mfma_f32_32x32x16_bf16 v[224:239], v[124:127], a[152:155], v[224:239]
    ds_read_b64_tr_b16 v[116:117], v22 offset:9216
    v_mfma_f32_32x32x16_bf16 v[240:255], v[124:127], a[156:159], v[240:255]
    buffer_load_dwordx4 v55, s[36:39], s70 offen offset:3072 lds
    s_add_u32 m0, s78, 114816
    s_mov_b32 s70, 128
    ds_read_b64_tr_b16 v[118:119], v22 offset:9984
    s_waitcnt lgkmcnt(4)
    v_mfma_f32_32x32x16_bf16 v[160:175], v[104:107], a[160:163], v[160:175]
    ds_read_b64_tr_b16 v[120:121], v22 offset:24608
    v_mfma_f32_32x32x16_bf16 v[176:191], v[104:107], a[164:167], v[176:191]
    buffer_load_dwordx4 v52, s[36:39], s70 offen offset:0 lds
    ds_read_b64_tr_b16 v[122:123], v22 offset:25376
    v_mfma_f32_32x32x16_bf16 v[160:175], v[108:111], a[168:171], v[160:175]
    ds_read_b64_tr_b16 v[124:125], v22 offset:27680
    v_mfma_f32_32x32x16_bf16 v[176:191], v[108:111], a[172:175], v[176:191]
    buffer_load_dwordx4 v53, s[36:39], s70 offen offset:1024 lds
    ds_read_b64_tr_b16 v[126:127], v22 offset:28448
    s_waitcnt lgkmcnt(4)
    v_mfma_f32_32x32x16_bf16 v[160:175], v[112:115], a[176:179], v[160:175]
    ds_read_b64_tr_b16 v[104:105], v22 offset:30752
    v_mfma_f32_32x32x16_bf16 v[176:191], v[112:115], a[180:183], v[176:191]
    buffer_load_dwordx4 v54, s[36:39], s70 offen offset:2048 lds
    ds_read_b64_tr_b16 v[106:107], v22 offset:31520
    v_mfma_f32_32x32x16_bf16 v[160:175], v[116:119], a[184:187], v[160:175]
    ds_read_b64_tr_b16 v[108:109], v22 offset:33824
    v_mfma_f32_32x32x16_bf16 v[176:191], v[116:119], a[188:191], v[176:191]
    buffer_load_dwordx4 v55, s[36:39], s70 offen offset:3072 lds
    s_add_u32 m0, s78, 131200
    s_mov_b32 s70, 0
    ds_read_b64_tr_b16 v[110:111], v22 offset:34592
    s_waitcnt lgkmcnt(4)
    v_mfma_f32_32x32x16_bf16 v[160:175], v[120:123], a[192:195], v[160:175]
    ds_read_b64_tr_b16 v[112:113], v22 offset:49216
    v_mfma_f32_32x32x16_bf16 v[176:191], v[120:123], a[196:199], v[176:191]
    buffer_load_dwordx4 v52, s[40:43], s70 offen offset:0 lds
    ds_read_b64_tr_b16 v[114:115], v22 offset:49984
    v_mfma_f32_32x32x16_bf16 v[160:175], v[124:127], a[200:203], v[160:175]
    ds_read_b64_tr_b16 v[116:117], v22 offset:52288
    v_mfma_f32_32x32x16_bf16 v[176:191], v[124:127], a[204:207], v[176:191]
    buffer_load_dwordx4 v53, s[40:43], s70 offen offset:1024 lds
    ds_read_b64_tr_b16 v[118:119], v22 offset:53056
    s_waitcnt lgkmcnt(4)
    v_mfma_f32_32x32x16_bf16 v[160:175], v[104:107], a[208:211], v[160:175]
    ds_read_b64_tr_b16 v[120:121], v22 offset:55360
    v_mfma_f32_32x32x16_bf16 v[176:191], v[104:107], a[212:215], v[176:191]
    buffer_load_dwordx4 v54, s[40:43], s70 offen offset:2048 lds
    ds_read_b64_tr_b16 v[122:123], v22 offset:56128
    v_mfma_f32_32x32x16_bf16 v[160:175], v[108:111], a[216:219], v[160:175]
    ds_read_b64_tr_b16 v[124:125], v22 offset:58432
    v_mfma_f32_32x32x16_bf16 v[176:191], v[108:111], a[220:223], v[176:191]
    buffer_load_dwordx4 v55, s[40:43], s70 offen offset:3072 lds
    s_add_u32 m0, s78, 0
    s_mov_b32 s70, 128
    ds_read_b64_tr_b16 v[126:127], v22 offset:59200
    s_waitcnt lgkmcnt(4)
    v_mfma_f32_32x32x16_bf16 v[160:175], v[112:115], a[224:227], v[160:175]
    ds_read_b64_tr_b16 v[104:105], v22 offset:32
    v_mfma_f32_32x32x16_bf16 v[176:191], v[112:115], a[228:231], v[176:191]
    buffer_load_dwordx4 v52, s[40:43], s70 offen offset:0 lds
    ds_read_b64_tr_b16 v[106:107], v22 offset:800
    v_mfma_f32_32x32x16_bf16 v[160:175], v[116:119], a[232:235], v[160:175]
    ds_read_b64_tr_b16 v[108:109], v22 offset:3104
    v_mfma_f32_32x32x16_bf16 v[176:191], v[116:119], a[236:239], v[176:191]
    buffer_load_dwordx4 v53, s[40:43], s70 offen offset:1024 lds
    ds_read_b64_tr_b16 v[110:111], v22 offset:3872
    s_waitcnt lgkmcnt(4)
    v_mfma_f32_32x32x16_bf16 v[160:175], v[120:123], a[240:243], v[160:175]
    ds_read_b64_tr_b16 v[112:113], v22 offset:6176
    v_mfma_f32_32x32x16_bf16 v[176:191], v[120:123], a[244:247], v[176:191]
    buffer_load_dwordx4 v54, s[40:43], s70 offen offset:2048 lds
    ds_read_b64_tr_b16 v[114:115], v22 offset:6944
    v_mfma_f32_32x32x16_bf16 v[160:175], v[124:127], a[248:251], v[160:175]
    ds_read_b64_tr_b16 v[116:117], v22 offset:9248
    v_mfma_f32_32x32x16_bf16 v[176:191], v[124:127], a[252:255], v[176:191]
    buffer_load_dwordx4 v55, s[40:43], s70 offen offset:3072 lds
    ds_read_b64_tr_b16 v[118:119], v22 offset:10016
    s_waitcnt lgkmcnt(4)
    v_mfma_f32_32x32x16_bf16 v[192:207], v[104:107], a[160:163], v[192:207]
    ds_read_b64_tr_b16 v[120:121], v22 offset:24640
    v_mfma_f32_32x32x16_bf16 v[208:223], v[104:107], a[164:167], v[208:223]
    ds_read_b64_tr_b16 v[122:123], v22 offset:25408
    v_mfma_f32_32x32x16_bf16 v[192:207], v[108:111], a[168:171], v[192:207]
    ds_read_b64_tr_b16 v[124:125], v22 offset:27712
    s_waitcnt vmcnt(21)
    v_cmp_ne_u32 vcc, s62, v5
    s_mov_b32 s81, 0
    s_cbranch_vccz L_g_ok
L_g:
    s_sleep 4
    buffer_load_dwordx2 v[4:5], v21, s[28:31], s76 offen sc1
    s_waitcnt vmcnt(0)
    v_cmp_ne_u32 vcc, s62, v5
    s_add_u32 s81, s81, 1
    s_cmp_gt_u32 s81, 200000
    s_cbranch_scc1 L_g_ok
    s_cbranch_vccnz L_g
L_g_ok:
    v_mov_b32 v5, v4
    s_nop 1
    v_permlane32_swap_b32 v4, v5
    s_nop 1
    v_sub_f32 v40, 1.0, v4
    v_sub_f32 v41, 1.0, v5
    v_cvt_pk_bf16_f32 v41, v40, v41
    v_lshlrev_b32 v40, 16, v41
    v_and_b32 v41, 0xffff0000, v41
    v_mfma_f32_32x32x16_bf16 v[208:223], v[108:111], a[172:175], v[208:223]
    ds_read_b64_tr_b16 v[126:127], v22 offset:28480
    s_waitcnt lgkmcnt(4)
    v_mfma_f32_32x32x16_bf16 v[192:207], v[112:115], a[176:179], v[192:207]
    ds_read_b64_tr_b16 v[104:105], v22 offset:30784
    s_add_u32 s72, s5, s54
    s_and_b32 s72, s72, 3
    s_and_b32 s73, s3, 1
    s_lshl1_add_u32 s72, s72, s73
    v_mfma_f32_32x32x16_bf16 v[208:223], v[112:115], a[180:183], v[208:223]
    ds_read_b64_tr_b16 v[106:107], v22 offset:31552
    s_lshl_b32 s72, s72, 10
    s_add_u32 s72, s72, s59
    s_add_u32 s63, s72, s67
    s_xor_b32 s73, s65, 1
    v_mfma_f32_32x32x16_bf16 v[192:207], v[116:119], a[184:187], v[192:207]
    ds_read_b64_tr_b16 v[108:109], v22 offset:33856
    s_mul_i32 s73, s73, 163840
    s_add_u32 s64, s72, s73
    s_mov_b32 s58, 0xffff0000
    v_mul_f32 v26, v160, v168
    v_mul_f32 v27, v161, v169
    v_mfma_f32_32x32x16_bf16 v[208:223], v[116:119], a[188:191], v[208:223]
    s_load_dwordx4 s[24:27], s[28:29], s75 glc
    ds_read_b64_tr_b16 v[110:111], v22 offset:34624
    v_mul_f32 v26, v26, v40
    v_mul_f32 v27, v27, v40
    v_cvt_pk_bf16_f32 v160, v26, v27
    v_mul_f32 v26, v162, v170
    s_waitcnt lgkmcnt(4)
    v_mfma_f32_32x32x16_bf16 v[192:207], v[120:123], a[192:195], v[192:207]
    ds_read_b64_tr_b16 v[112:113], v22 offset:49248
    v_mul_f32 v27, v163, v171
    v_mul_f32 v26, v26, v40
    v_mul_f32 v27, v27, v40
    v_cvt_pk_bf16_f32 v161, v26, v27
    v_mul_f32 v26, v164, v172
    v_mfma_f32_32x32x16_bf16 v[208:223], v[120:123], a[196:199], v[208:223]
    ds_read_b64_tr_b16 v[114:115], v22 offset:50016
    v_mul_f32 v27, v165, v173
    v_mul_f32 v26, v26, v40
    v_mul_f32 v27, v27, v40
    v_cvt_pk_bf16_f32 v162, v26, v27
    v_mfma_f32_32x32x16_bf16 v[192:207], v[124:127], a[200:203], v[192:207]
    ds_read_b64_tr_b16 v[116:117], v22 offset:52320
    v_mul_f32 v26, v166, v174
    v_mul_f32 v27, v167, v175
    v_mul_f32 v26, v26, v40
    v_mul_f32 v27, v27, v40
    v_cvt_pk_bf16_f32 v163, v26, v27
    v_mfma_f32_32x32x16_bf16 v[208:223], v[124:127], a[204:207], v[208:223]
    ds_read_b64_tr_b16 v[118:119], v22 offset:53088
    buffer_store_dwordx4 v[160:163], v23, s[28:31], s63 offen sc1
    s_add_u32 s63, s63, 8192
    v_mul_f32 v26, v176, v184
    s_waitcnt lgkmcnt(4)
    v_mfma_f32_32x32x16_bf16 v[192:207], v[104:107], a[208:211], v[192:207]
    ds_read_b64_tr_b16 v[120:121], v22 offset:55392
    v_mul_f32 v27, v177, v185
    v_mul_f32 v26, v26, v41
    v_mul_f32 v27, v27, v41
    v_cvt_pk_bf16_f32 v176, v26, v27
    v_mfma_f32_32x32x16_bf16 v[208:223], v[104:107], a[212:215], v[208:223]
    ds_read_b64_tr_b16 v[122:123], v22 offset:56160
    v_mul_f32 v26, v178, v186
    v_mul_f32 v27, v179, v187
    v_mul_f32 v26, v26, v41
    v_mul_f32 v27, v27, v41
    v_cvt_pk_bf16_f32 v177, v26, v27
    v_mfma_f32_32x32x16_bf16 v[192:207], v[108:111], a[216:219], v[192:207]
    ds_read_b64_tr_b16 v[124:125], v22 offset:58464
    v_mul_f32 v26, v180, v188
    v_mul_f32 v27, v181, v189
    v_mul_f32 v26, v26, v41
    v_mul_f32 v27, v27, v41
    v_mfma_f32_32x32x16_bf16 v[208:223], v[108:111], a[220:223], v[208:223]
    ds_read_b64_tr_b16 v[126:127], v22 offset:59232
    v_cvt_pk_bf16_f32 v178, v26, v27
    v_mul_f32 v26, v182, v190
    v_mul_f32 v27, v183, v191
    v_mul_f32 v26, v26, v41
    v_mul_f32 v27, v27, v41
    s_waitcnt lgkmcnt(4)
    v_mfma_f32_32x32x16_bf16 v[192:207], v[112:115], a[224:227], v[192:207]
    s_waitcnt lgkmcnt(0)
    s_add_u32 s24, s24, s25
    s_add_u32 s24, s24, s26
    s_add_u32 s24, s24, s27
    s_mul_i32 s25, s62, 4
    s_cmp_eq_u32 s24, s25
    s_mov_b32 s81, 0
    s_cbranch_scc1 L_ph_ok
L_ph:
    s_sleep 1
    s_add_u32 s81, s81, 1
    s_cmp_gt_u32 s81, 200000
    s_cbranch_scc1 L_ph_ok
    s_load_dwordx4 s[24:27], s[28:29], s75 glc
    s_waitcnt lgkmcnt(0)
    s_add_u32 s24, s24, s25
    s_add_u32 s24, s24, s26
    s_add_u32 s24, s24, s27
    s_mul_i32 s25, s62, 4
    s_cmp_eq_u32 s24, s25
    s_cbranch_scc0 L_ph
L_ph_ok:
    s_mov_b32 s71, 98304
    buffer_load_dwordx4 a[0:3], v3, s[28:31], s71 offen offset:0 sc1
    ds_read_b64_tr_b16 v[104:105], v22 offset:64
    v_cvt_pk_bf16_f32 v179, v26, v27
    buffer_store_dwordx4 v[176:179], v23, s[28:31], s64 offen sc1
    s_add_u32 s64, s64, 8192
    v_mfma_f32_32x32x16_bf16 v[208:223], v[112:115], a[228:231], v[208:223]
    ds_read_b64_tr_b16 v[106:107], v22 offset:832
    v_mfma_f32_32x32x16_bf16 v[192:207], v[116:119], a[232:235], v[192:207]
    ds_read_b64_tr_b16 v[108:109], v22 offset:3136
    v_mfma_f32_32x32x16_bf16 v[208:223], v[116:119], a[236:239], v[208:223]
    ds_read_b64_tr_b16 v[110:111], v22 offset:3904
    v_mfma_f32_32x32x16_bf16 v[192:207], v[120:123], a[240:243], v[192:207]
    buffer_load_dwordx4 a[4:7], v3, s[28:31], s71 offen offset:1024 sc1
    ds_read_b64_tr_b16 v[112:113], v22 offset:6208
    v_mfma_f32_32x32x16_bf16 v[208:223], v[120:123], a[244:247], v[208:223]
    ds_read_b64_tr_b16 v[114:115], v22 offset:6976
    v_mfma_f32_32x32x16_bf16 v[192:207], v[124:127], a[248:251], v[192:207]
    buffer_load_dwordx4 a[8:11], v3, s[28:31], s71 offen offset:2048 sc1
    ds_read_b64_tr_b16 v[116:117], v22 offset:9280
    v_mfma_f32_32x32x16_bf16 v[208:223], v[124:127], a[252:255], v[208:223]
    ds_read_b64_tr_b16 v[118:119], v22 offset:10048
    s_waitcnt lgkmcnt(4)
    v_mfma_f32_32x32x16_bf16 v[224:239], v[104:107], a[160:163], v[224:239]
    buffer_load_dwordx4 a[12:15], v3, s[28:31], s71 offen offset:3072 sc1
    s_mov_b32 s71, 102400
    ds_read_b64_tr_b16 v[120:121], v22 offset:24672
    v_mfma_f32_32x32x16_bf16 v[240:255], v[104:107], a[164:167], v[240:255]
    ds_read_b64_tr_b16 v[122:123], v22 offset:25440
    v_mfma_f32_32x32x16_bf16 v[224:239], v[108:111], a[168:171], v[224:239]
    buffer_load_dwordx4 a[16:19], v3, s[28:31], s71 offen offset:0 sc1
    ds_read_b64_tr_b16 v[124:125], v22 offset:27744
    s_nop 5
    v_mfma_f32_32x32x16_bf16 v[240:255], v[108:111], a[172:175], v[240:255]
    ds_read_b64_tr_b16 v[126:127], v22 offset:28512
    v_mul_f32 v26, v192, v200
    v_mul_f32 v27, v193, v201
    buffer_load_dwordx4 a[20:23], v3, s[28:31], s71 offen offset:1024 sc1
    s_waitcnt lgkmcnt(4)
    v_mfma_f32_32x32x16_bf16 v[224:239], v[112:115], a[176:179], v[224:239]
    ds_read_b64_tr_b16 v[104:105], v22 offset:30816
    v_mul_f32 v26, v26, v40
    v_mul_f32 v27, v27, v40
    v_cvt_pk_bf16_f32 v192, v26, v27
    v_mul_f32 v26, v194, v202
    v_mfma_f32_32x32x16_bf16 v[240:255], v[112:115], a[180:183], v[240:255]
    ds_read_b64_tr_b16 v[106:107], v22 offset:31584
    buffer_load_dwordx4 a[24:27], v3, s[28:31], s71 offen offset:2048 sc1
    v_mul_f32 v27, v195, v203
    v_mul_f32 v26, v26, v40
    v_mul_f32 v27, v27, v40
    v_mfma_f32_32x32x16_bf16 v[224:239], v[116:119], a[184:187], v[224:239]
    ds_read_b64_tr_b16 v[108:109], v22 offset:33888
    v_cvt_pk_bf16_f32 v193, v26, v27
    v_mul_f32 v26, v196, v204
    v_mul_f32 v27, v197, v205
    v_mul_f32 v26, v26, v40
    v_mfma_f32_32x32x16_bf16 v[240:255], v[116:119], a[188:191], v[240:255]
    buffer_load_dwordx4 a[28:31], v3, s[28:31], s71 offen offset:3072 sc1
    s_mov_b32 s71, 131072
    ds_read_b64_tr_b16 v[110:111], v22 offset:34656
    v_mul_f32 v27, v27, v40
    v_cvt_pk_bf16_f32 v194, v26, v27
    v_mul_f32 v26, v198, v206
    v_mul_f32 v27, v199, v207
    s_waitcnt lgkmcnt(4)
    v_mfma_f32_32x32x16_bf16 v[224:239], v[120:123], a[192:195], v[224:239]
    ds_read_b64_tr_b16 v[112:113], v22 offset:49280
    v_mul_f32 v26, v26, v40
    v_mul_f32 v27, v27, v40
    buffer_load_dwordx4 a[32:35], v3, s[28:31], s71 offen offset:0 sc1
    v_cvt_pk_bf16_f32 v195, v26, v27
    v_mfma_f32_32x32x16_bf16 v[240:255], v[120:123], a[196:199], v[240:255]
    ds_read_b64_tr_b16 v[114:115], v22 offset:50048
    buffer_store_dwordx4 v[192:195], v23, s[28:31], s63 offen sc1
    s_add_u32 s63, s63, 8192
    v_mul_f32 v26, v208, v216
    v_mfma_f32_32x32x16_bf16 v[224:239], v[124:127], a[200:203], v[224:239]
    ds_read_b64_tr_b16 v[116:117], v22 offset:52352
    v_mul_f32 v27, v209, v217
    v_mul_f32 v26, v26, v41
    v_mul_f32 v27, v27, v41
    v_cvt_pk_bf16_f32 v208, v26, v27
    v_mfma_f32_32x32x16_bf16 v[240:255], v[124:127], a[204:207], v[240:255]
    ds_read_b64_tr_b16 v[118:119], v22 offset:53120
    v_mul_f32 v26, v210, v218
    v_mul_f32 v27, v211, v219
    v_mul_f32 v26, v26, v41
    v_mul_f32 v27, v27, v41
    s_waitcnt lgkmcnt(4)
    v_mfma_f32_32x32x16_bf16 v[224:239], v[104:107], a[208:211], v[224:239]
    ds_read_b64_tr_b16 v[120:121], v22 offset:55424
    v_cvt_pk_bf16_f32 v209, v26, v27
    v_mul_f32 v26, v212, v220
    v_mul_f32 v27, v213, v221
    buffer_load_dwordx4 a[36:39], v3, s[28:31], s71 offen offset:1024 sc1
    v_mfma_f32_32x32x16_bf16 v[240:255], v[104:107], a[212:215], v[240:255]
    ds_read_b64_tr_b16 v[122:123], v22 offset:56192
    s_and_b32 s69, s3, 1
    s_lshl1_add_u32 s69, s7, s69
    s_lshl_b32 s69, s69, 2
    s_add_u32 s69, s69, s68
    s_waitcnt vmcnt(10)
    s_mov_b64 exec, 1
    buffer_store_dword v24, v23, s[28:31], s69 offen sc1
    s_mov_b64 exec, -1
    v_mul_f32 v26, v26, v41
    v_mul_f32 v27, v27, v41
    buffer_load_dwordx4 a[40:43], v3, s[28:31], s71 offen offset:2048 sc1
    v_cvt_pk_bf16_f32 v210, v26, v27
    v_mul_f32 v26, v214, v222
    v_mfma_f32_32x32x16_bf16 v[224:239], v[108:111], a[216:219], v[224:239]
    ds_read_b64_tr_b16 v[124:125], v22 offset:58496
    v_mul_f32 v27, v215, v223
    v_mul_f32 v26, v26, v41
    v_mul_f32 v27, v27, v41
    v_cvt_pk_bf16_f32 v211, v26, v27
    v_mfma_f32_32x32x16_bf16 v[240:255], v[108:111], a[220:223], v[240:255]
    buffer_load_dwordx4 a[44:47], v3, s[28:31], s71 offen offset:3072 sc1
    s_mov_b32 s71, 135168
    ds_read_b64_tr_b16 v[126:127], v22 offset:59264
    buffer_store_dwordx4 v[208:211], v23, s[28:31], s64 offen sc1
    s_add_u32 s64, s64, 8192
    s_waitcnt lgkmcnt(4)
    v_mfma_f32_32x32x16_bf16 v[224:239], v[112:115], a[224:227], v[224:239]
    v_mfma_f32_32x32x16_bf16 v[240:255], v[112:115], a[228:231], v[240:255]
    s_waitcnt lgkmcnt(0)
    s_barrier
    s_add_u32 m0, s78, 16384
    s_add_u32 s70, s55, 0
    v_mfma_f32_32x32x16_bf16 v[224:239], v[116:119], a[232:235], v[224:239]
    v_mfma_f32_32x32x16_bf16 v[240:255], v[116:119], a[236:239], v[240:255]
    buffer_load_dwordx4 a[48:51], v3, s[28:31], s71 offen offset:0 sc1
    v_mfma_f32_32x32x16_bf16 v[224:239], v[120:123], a[240:243], v[224:239]
    v_mfma_f32_32x32x16_bf16 v[240:255], v[120:123], a[244:247], v[240:255]
    buffer_load_dwordx4 a[52:55], v3, s[28:31], s71 offen offset:1024 sc1
    v_mfma_f32_32x32x16_bf16 v[224:239], v[124:127], a[248:251], v[224:239]
    v_mfma_f32_32x32x16_bf16 v[240:255], v[124:127], a[252:255], v[240:255]
    buffer_load_dwordx4 a[56:59], v3, s[28:31], s71 offen offset:2048 sc1
    ds_read_b128 v[64:67], v10 offset:4096
    ds_read_b128 v[68:71], v10 offset:8192
    ds_read_b128 v[72:75], v10 offset:12288
    ds_read_b128 v[76:79], v11 offset:4096
    ds_read_b128 v[80:83], v11 offset:8192
    ds_read_b128 v[84:87], v11 offset:12288
    buffer_load_dwordx4 a[60:63], v3, s[28:31], s71 offen offset:3072 sc1
    ds_read_b128 v[88:91], v12 offset:4096
    ds_read_b128 v[92:95], v12 offset:8192
    s_nop 7
    buffer_load_dwordx4 v56, s[44:47], s70 offen offset:0 lds
    s_nop 2
    v_pk_mul_f32 v[26:27], v[224:225], v[232:233]
    v_pk_mul_f32 v[26:27], v[26:27], v[40:41] op_sel:[0,0] op_sel_hi:[1,0]
    v_cvt_pk_bf16_f32 v224, v26, v27
    v_pk_mul_f32 v[28:29], v[226:227], v[234:235]
    v_pk_mul_f32 v[28:29], v[28:29], v[40:41] op_sel:[0,0] op_sel_hi:[1,0]
    v_cvt_pk_bf16_f32 v225, v28, v29
    v_pk_mul_f32 v[26:27], v[228:229], v[236:237]
    v_pk_mul_f32 v[26:27], v[26:27], v[40:41] op_sel:[0,0] op_sel_hi:[1,0]
    buffer_load_dwordx4 v57, s[44:47], s70 offen offset:1024 lds
    v_cvt_pk_bf16_f32 v226, v26, v27
    v_pk_mul_f32 v[28:29], v[230:231], v[238:239]
    v_pk_mul_f32 v[28:29], v[28:29], v[40:41] op_sel:[0,0] op_sel_hi:[1,0]
    v_cvt_pk_bf16_f32 v227, v28, v29
    buffer_store_dwordx4 v[224:227], v23, s[28:31], s63 offen sc1
    v_pk_mul_f32 v[26:27], v[240:241], v[248:249]
    v_pk_mul_f32 v[26:27], v[26:27], v[40:41] op_sel:[0,1] op_sel_hi:[1,1]
    v_cvt_pk_bf16_f32 v240, v26, v27
    v_pk_mul_f32 v[28:29], v[242:243], v[250:251]
    v_pk_mul_f32 v[28:29], v[28:29], v[40:41] op_sel:[0,1] op_sel_hi:[1,1]
    v_cvt_pk_bf16_f32 v241, v28, v29
    v_pk_mul_f32 v[26:27], v[244:245], v[252:253]
    v_pk_mul_f32 v[26:27], v[26:27], v[40:41] op_sel:[0,1] op_sel_hi:[1,1]
    v_cvt_pk_bf16_f32 v242, v26, v27
    v_pk_mul_f32 v[28:29], v[246:247], v[254:255]
    v_pk_mul_f32 v[28:29], v[28:29], v[40:41] op_sel:[0,1] op_sel_hi:[1,1]
    v_cvt_pk_bf16_f32 v243, v28, v29
    buffer_store_dwordx4 v[240:243], v23, s[28:31], s64 offen sc1
    s_waitcnt lgkmcnt(6)
    v_mfma_f32_32x32x16_bf16 v[176:191], v[64:67], a[0:3], 0
    ds_read_b128 v[96:99], v12 offset:12288
    s_load_dwordx8 s[16:23], s[28:29], s68 glc
    v_mfma_f32_32x32x16_bf16 v[192:207], v[68:71], a[0:3], 0
    ds_read_b128 v[100:103], v13 offset:4096
    s_waitcnt lgkmcnt(6)
    v_mfma_f32_32x32x16_bf16 v[208:223], v[72:75], a[0:3], 0
    ds_read_b128 v[64:67], v13 offset:8192
    v_subrev_u32 v14, 98432, v10
    s_waitcnt vmcnt(21)
    buffer_load_dwordx4 v58, s[44:47], s70 offen offset:2048 lds
    v_mfma_f32_32x32x16_bf16 v[176:191], v[76:79], a[4:7], v[176:191]
    ds_read_b128 v[68:71], v13 offset:12288
    v_subrev_u32 v15, 98432, v11
    v_subrev_u32 v16, 98432, v12
    s_waitcnt lgkmcnt(6)
    v_mfma_f32_32x32x16_bf16 v[192:207], v[80:83], a[4:7], v[192:207]
    ds_read_b128 v[72:75], v10 offset:20480
    buffer_load_dwordx4 v59, s[44:47], s70 offen offset:3072 lds
    s_add_u32 m0, s78, 32768
    s_add_u32 s70, s56, 0
    v_subrev_u32 v17, 98432, v13
    v_mfma_f32_32x32x16_bf16 v[208:223], v[84:87], a[4:7], v[208:223]
    ds_read_b128 v[76:79], v10 offset:24576
    v_add_u32 v6, 151552, v60
    v_add_u32 v7, 151552, v61
    s_waitcnt vmcnt(22)
    s_waitcnt lgkmcnt(6)
    buffer_load_dwordx4 v56, s[44:47], s70 offen offset:0 lds
    v_mfma_f32_32x32x16_bf16 v[176:191], v[88:91], a[8:11], v[176:191]
    ds_read_b128 v[80:83], v10 offset:28672
    v_and_b32 v26, 31, v1
    v_bfe_u32 v27, v1, 3, 1
    v_mfma_f32_32x32x16_bf16 v[192:207], v[92:95], a[8:11], v[192:207]
    ds_read_b128 v[84:87], v11 offset:20480
    buffer_load_dwordx4 v57, s[44:47], s70 offen offset:1024 lds
    v_xor_b32 v26, v26, v27
    s_waitcnt lgkmcnt(6)
    v_mfma_f32_32x32x16_bf16 v[208:223], v[96:99], a[8:11], v[208:223]
    ds_read_b128 v[88:91], v11 offset:24576
    v_lshlrev_b32 v26, 7, v26
    v_lshrrev_b32 v27, 5, v1
    s_waitcnt vmcnt(23)
    v_mfma_f32_32x32x16_bf16 v[176:191], v[100:103], a[12:15], v[176:191]
    s_waitcnt lgkmcnt(0)
    s_add_u32 s16, s16, s17
    s_add_u32 s16, s16, s18
    s_add_u32 s16, s16, s19
    s_add_u32 s16, s16, s20
    s_add_u32 s16, s16, s21
    s_add_u32 s16, s16, s22
    s_add_u32 s16, s16, s23
    s_mul_i32 s17, s62, 8
    s_cmp_eq_u32 s16, s17
    s_mov_b32 s81, 0
    s_cbranch_scc1 L_pH1_ok
L_pH1:
    s_sleep 1
    s_add_u32 s81, s81, 1
    s_cmp_gt_u32 s81, 200000
    s_cbranch_scc1 L_pH1_ok
    s_load_dwordx8 s[16:23], s[28:29], s68 glc
    s_waitcnt lgkmcnt(0)
    s_add_u32 s16, s16, s17
    s_add_u32 s16, s16, s18
    s_add_u32 s16, s16, s19
    s_add_u32 s16, s16, s20
    s_add_u32 s16, s16, s21
    s_add_u32 s16, s16, s22
    s_add_u32 s16, s16, s23
    s_mul_i32 s17, s62, 8
    s_cmp_eq_u32 s16, s17
    s_cbranch_scc0 L_pH1
L_pH1_ok:
    s_mov_b32 s71, 0
    buffer_load_dwordx4 a[64:67], v2, s[28:31], s71 offen offset:0 sc1
    ds_read_b128 v[92:95], v11 offset:28672
    v_and_b32 v28, 7, v1
    v_xor_b32 v27, v27, v28
    v_mfma_f32_32x32x16_bf16 v[192:207], v[64:67], a[12:15], v[192:207]
    ds_read_b128 v[96:99], v12 offset:20480
    s_lshr_b32 s72, s3, 1
    s_lshl_b32 s72, s72, 14
    v_mfma_f32_32x32x16_bf16 v[208:223], v[68:71], a[12:15], v[208:223]
    buffer_load_dwordx4 a[68:71], v2, s[28:31], s71 offen offset:1024 sc1
    ds_read_b128 v[100:103], v12 offset:24576
    s_and_b32 s73, s3, 1
    s_lshl_b32 s73, s73, 12
    s_waitcnt vmcnt(24)
    v_mfma_f32_32x32x16_bf16 v[176:191], v[72:75], a[16:19], v[176:191]
    ds_read_b128 v[64:67], v12 offset:28672
    s_add_u32 s72, s72, s73
    s_add_u32 s72, s72, 102528
    buffer_load_dwordx4 a[72:75], v2, s[28:31], s71 offen offset:2048 sc1
    v_mfma_f32_32x32x16_bf16 v[192:207], v[76:79], a[16:19], v[192:207]
    ds_read_b128 v[68:71], v13 offset:20480
    v_lshl_add_u32 v26, v27, 4, v26
    v_mfma_f32_32x32x16_bf16 v[208:223], v[80:83], a[16:19], v[208:223]
    ds_read_b128 v[72:75], v13 offset:24576
    buffer_load_dwordx4 a[76:79], v2, s[28:31], s71 offen offset:3072 sc1
    s_mov_b32 s71, 4096
    v_xor_b32 v132, 0, v26
    v_add_u32 v132, s72, v132
    s_and_b32 s69, s3, 1
    s_lshl1_add_u32 s69, s7, s69
    s_lshl_b32 s69, s69, 2
    s_add_u32 s69, s69, s74
    s_waitcnt vmcnt(8)
    s_mov_b64 exec, 1
    buffer_store_dword v24, v23, s[28:31], s69 offen sc1
    s_mov_b64 exec, -1
    v_mfma_f32_32x32x16_bf16 v[176:191], v[84:87], a[20:23], v[176:191]
    buffer_load_dwordx4 a[80:83], v2, s[28:31], s71 offen offset:0 sc1
    ds_read_b128 v[76:79], v13 offset:28672
    v_xor_b32 v133, 32, v26
    v_add_u32 v133, s72, v133
    s_waitcnt lgkmcnt(6)
    v_mfma_f32_32x32x16_bf16 v[192:207], v[88:91], a[20:23], v[192:207]
    ds_read_b128 v[80:83], v10 offset:36864
    v_xor_b32 v134, 64, v26
    v_add_u32 v134, s72, v134
    v_mfma_f32_32x32x16_bf16 v[208:223], v[92:95], a[20:23], v[208:223]
    buffer_load_dwordx4 a[84:87], v2, s[28:31], s71 offen offset:1024 sc1
    ds_read_b128 v[84:87], v10 offset:40960
    v_xor_b32 v135, 96, v26
    v_add_u32 v135, s72, v135
    s_waitcnt lgkmcnt(6)
    v_mfma_f32_32x32x16_bf16 v[176:191], v[96:99], a[24:27], v[176:191]
    ds_read_b128 v[88:91], v10 offset:45056
    v_bfe_u32 v26, v1, 3, 2
    v_mfma_f32_32x32x16_bf16 v[192:207], v[100:103], a[24:27], v[192:207]
    buffer_load_dwordx4 a[88:91], v2, s[28:31], s71 offen offset:2048 sc1
    ds_read_b128 v[92:95], v11 offset:36864
    v_lshlrev_b32 v26, 3, v26
    v_lshrrev_b32 v27, 5, v1
    s_waitcnt lgkmcnt(6)
    v_mfma_f32_32x32x16_bf16 v[208:223], v[64:67], a[24:27], v[208:223]
    ds_read_b128 v[96:99], v11 offset:40960
    v_lshl_add_u32 v26, v27, 2, v26
    v_lshlrev_b32 v30, 2, v26
    buffer_load_dwordx4 a[92:95], v2, s[28:31], s71 offen offset:3072 sc1
    v_mfma_f32_32x32x16_bf16 v[176:191], v[68:71], a[28:31], v[176:191]
    ds_read_b128 v[100:103], v11 offset:45056
    ds_bpermute_b32 v128, v30, v4 offset:0
    s_waitcnt lgkmcnt(7)
    v_mfma_f32_32x32x16_bf16 v[192:207], v[72:75], a[28:31], v[192:207]
    ds_read_b128 v[64:67], v12 offset:36864
    buffer_load_dwordx4 v58, s[44:47], s70 offen offset:2048 lds
    ds_bpermute_b32 v129, v30, v4 offset:4
    ds_bpermute_b32 v130, v30, v4 offset:8
    v_mfma_f32_32x32x16_bf16 v[208:223], v[76:79], a[28:31], v[208:223]
    ds_read_b128 v[68:71], v12 offset:40960
    ds_bpermute_b32 v131, v30, v4 offset:12
    s_waitcnt lgkmcnt(10)
    v_mfma_f32_32x32x16_bf16 v[176:191], v[80:83], a[32:35], v[176:191]
    buffer_load_dwordx4 v59, s[44:47], s70 offen offset:3072 lds
    s_add_u32 m0, s78, 49216
    s_add_u32 s70, s55, 16384
    ds_read_b128 v[72:75], v13 offset:36864
    v_bfe_u32 v29, v1, 3, 1
    v_xor_b32 v26, v26, v29
    v_mfma_f32_32x32x16_bf16 v[192:207], v[84:87], a[32:35], v[192:207]
    ds_read_b128 v[76:79], v13 offset:40960
    v_lshlrev_b32 v26, 7, v26
    buffer_load_dwordx4 v56, s[44:47], s70 offen offset:0 lds
    v_lshlrev_b32 v27, 2, v27
    s_waitcnt lgkmcnt(10)
    v_mfma_f32_32x32x16_bf16 v[208:223], v[88:91], a[32:35], v[208:223]
    ds_read_b128 v[80:83], v14 offset:4096
    v_xor_b32 v27, v27, v28
    v_lshl_add_u32 v26, v27, 4, v26
    v_mfma_f32_32x32x16_bf16 v[176:191], v[92:95], a[36:39], v[176:191]
    ds_read_b128 v[84:87], v14 offset:8192
    buffer_load_dwordx4 v57, s[44:47], s70 offen offset:1024 lds
    v_xor_b32 v136, 0, v26
    s_waitcnt lgkmcnt(10)
    v_mfma_f32_32x32x16_bf16 v[192:207], v[96:99], a[36:39], v[192:207]
    ds_read_b128 v[88:91], v15 offset:4096
    v_add_u32 v136, s72, v136
    v_xor_b32 v137, 144, v26
    v_mfma_f32_32x32x16_bf16 v[208:223], v[100:103], a[36:39], v[208:223]
    ds_read_b128 v[92:95], v15 offset:8192
    buffer_load_dwordx4 v58, s[44:47], s70 offen offset:2048 lds
    v_add_u32 v137, s72, v137
    v_xor_b32 v138, 288, v26
    s_waitcnt lgkmcnt(7)
    v_mfma_f32_32x32x16_bf16 v[176:191], v[64:67], a[40:43], v[176:191]
    ds_read_b128 v[96:99], v16 offset:4096
    v_add_u32 v138, s72, v138
    v_mfma_f32_32x32x16_bf16 v[192:207], v[68:71], a[40:43], v[192:207]
    buffer_load_dwordx4 v59, s[44:47], s70 offen offset:3072 lds
    s_add_u32 m0, s78, 65600
    s_add_u32 s70, s56, 16384
    ds_read_b128 v[100:103], v16 offset:8192
    v_xor_b32 v139, 432, v26
    v_add_u32 v139, s72, v139
    s_waitcnt lgkmcnt(6)
    v_mfma_f32_32x32x16_bf16 v[176:191], v[72:75], a[44:47], v[176:191]
    ds_read_b128 v[64:67], v17 offset:4096
    buffer_load_dwordx4 v56, s[12:15], s70 offen offset:0 lds
    s_lshl_b32 s72, s4, 4
    s_lshl_b32 s73, s7, 2
    v_mfma_f32_32x32x16_bf16 v[192:207], v[76:79], a[44:47], v[192:207]
    ds_read_b128 v[68:71], v17 offset:8192
    s_add_u32 s72, s72, s73
    s_add_u32 s72, s72, s54
    s_waitcnt lgkmcnt(6)
    v_mfma_f32_32x32x16_bf16 v[176:191], v[80:83], a[48:51], v[176:191]
    buffer_load_dwordx4 v57, s[12:15], s70 offen offset:1024 lds
    ds_read_b128 v[72:75], v14 offset:12288
    s_add_u32 s59, s79, 16777216
    s_xor_b32 s73, s72, 1
    v_mfma_f32_32x32x16_bf16 v[192:207], v[84:87], a[48:51], v[192:207]
    ds_read_b128 v[76:79], v15 offset:12288
    s_mul_i32 s73, s73, 24576
    s_waitcnt lgkmcnt(6)
    v_mfma_f32_32x32x16_bf16 v[176:191], v[88:91], a[52:55], v[176:191]
    buffer_load_dwordx4 v58, s[12:15], s70 offen offset:2048 lds
    ds_read_b128 v[80:83], v16 offset:12288
    s_add_u32 s73, s73, s59
    s_add_u32 s52, s73, 0
    v_mfma_f32_32x32x16_bf16 v[192:207], v[92:95], a[52:55], v[192:207]
    ds_read_b128 v[84:87], v17 offset:12288
    s_xor_b32 s73, s72, 2
    s_mul_i32 s73, s73, 24576
    s_waitcnt lgkmcnt(6)
    buffer_load_dwordx4 v59, s[12:15], s70 offen offset:3072 lds
    s_add_u32 m0, s78, 81984
    s_add_u32 s70, s55, 32768
    v_mfma_f32_32x32x16_bf16 v[176:191], v[96:99], a[56:59], v[176:191]
    ds_read_b128 v[88:91], v12 offset:45056
    s_add_u32 s73, s73, s59
    v_mfma_f32_32x32x16_bf16 v[192:207], v[100:103], a[56:59], v[192:207]
    buffer_load_dwordx4 v56, s[44:47], s70 offen offset:0 lds
    s_load_dwordx8 s[16:23], s[28:29], s74 glc
    ds_read_b128 v[92:95], v13 offset:45056
    s_add_u32 s53, s73, 8192
    s_xor_b32 s73, s72, 3
    s_waitcnt lgkmcnt(6)
    v_mfma_f32_32x32x16_bf16 v[176:191], v[64:67], a[60:63], v[176:191]
    s_mul_i32 s73, s73, 24576
    s_add_u32 s73, s73, s59
    v_mfma_f32_32x32x16_bf16 v[192:207], v[68:71], a[60:63], v[192:207]
    buffer_load_dwordx4 v57, s[44:47], s70 offen offset:1024 lds
    s_add_u32 s80, s73, 16384
    s_waitcnt lgkmcnt(4)
    v_mfma_f32_32x32x16_bf16 v[208:223], v[72:75], a[48:51], v[208:223]
    s_mul_i32 s72, s72, 24576
    s_add_u32 s59, s59, s72
    v_mfma_f32_32x32x16_bf16 v[208:223], v[76:79], a[52:55], v[208:223]
    buffer_load_dwordx4 v58, s[44:47], s70 offen offset:2048 lds
    s_nop 7
    s_waitcnt lgkmcnt(2)
    v_mfma_f32_32x32x16_bf16 v[208:223], v[80:83], a[56:59], v[208:223]
    v_mul_f32 v176, v176, v4
    v_mul_f32 v177, v177, v4
    buffer_load_dwordx4 v59, s[44:47], s70 offen offset:3072 lds
    s_add_u32 m0, s78, 151552
    s_add_u32 s70, s56, 32768
    v_mul_f32 v178, v178, v4
    v_mul_f32 v179, v179, v4
    v_mul_f32 v180, v180, v4
    v_mul_f32 v181, v181, v4
    v_mul_f32 v182, v182, v4
    v_mul_f32 v183, v183, v4
    v_mfma_f32_32x32x16_bf16 v[208:223], v[84:87], a[60:63], v[208:223]
    v_mul_f32 v184, v184, v4
    v_mul_f32 v185, v185, v4
    s_waitcnt lgkmcnt(0)
    s_add_u32 s16, s16, s17
    s_add_u32 s16, s16, s18
    s_add_u32 s16, s16, s19
    s_add_u32 s16, s16, s20
    s_add_u32 s16, s16, s21
    s_add_u32 s16, s16, s22
    s_add_u32 s16, s16, s23
    s_mul_i32 s17, s62, 8
    s_cmp_eq_u32 s16, s17
    s_mov_b32 s81, 0
    s_cbranch_scc1 L_pH_ok
L_pH:
    s_sleep 1
    s_add_u32 s81, s81, 1
    s_cmp_gt_u32 s81, 200000
    s_cbranch_scc1 L_pH_ok
    s_load_dwordx8 s[16:23], s[28:29], s74 glc
    s_waitcnt lgkmcnt(0)
    s_add_u32 s16, s16, s17
    s_add_u32 s16, s16, s18
    s_add_u32 s16, s16, s19
    s_add_u32 s16, s16, s20
    s_add_u32 s16, s16, s21
    s_add_u32 s16, s16, s22
    s_add_u32 s16, s16, s23
    s_mul_i32 s17, s62, 8
    s_cmp_eq_u32 s16, s17
    s_cbranch_scc0 L_pH
L_pH_ok:
    buffer_load_dwordx4 v56, s[12:15], s70 offen offset:0 lds
    s_mov_b32 s71, 8192
    v_mul_f32 v186, v186, v4
    v_mul_f32 v187, v187, v4
    v_mul_f32 v188, v188, v4
    v_mul_f32 v189, v189, v4
    v_mul_f32 v190, v190, v4
    v_mul_f32 v191, v191, v4
    v_mfma_f32_32x32x16_bf16 v[208:223], v[88:91], a[40:43], v[208:223]
    v_mul_f32 v192, v192, v4
    v_mul_f32 v193, v193, v4
    buffer_load_dwordx4 v57, s[12:15], s70 offen offset:1024 lds
    v_mul_f32 v194, v194, v4
    v_mul_f32 v195, v195, v4
    v_mul_f32 v196, v196, v4
    v_mul_f32 v197, v197, v4
    v_mul_f32 v198, v198, v4
    v_mul_f32 v199, v199, v4
    v_mfma_f32_32x32x16_bf16 v[208:223], v[92:95], a[44:47], v[208:223]
    v_mul_f32 v200, v200, v4
    v_mul_f32 v201, v201, v4
    v_mul_f32 v202, v202, v4
    v_mul_f32 v203, v203, v4
    v_mul_f32 v204, v204, v4
    buffer_load_dwordx4 v58, s[12:15], s70 offen offset:2048 lds
    v_mul_f32 v205, v205, v4
    v_mul_f32 v206, v206, v4
    v_mul_f32 v207, v207, v4
    s_waitcnt vmcnt(15) lgkmcnt(0)
    s_barrier
    ds_read_b64_tr_b16 v[96:97], v61 offset:16384
    ds_read_b64_tr_b16 v[98:99], v61 offset:17408
    buffer_load_dwordx4 v59, s[12:15], s70 offen offset:3072 lds
    ds_read_b64_tr_b16 v[100:101], v60 offset:18432
    ds_read_b64_tr_b16 v[102:103], v60 offset:19456
    ds_read_b64_tr_b16 v[64:65], v61 offset:20480
    ds_read_b64_tr_b16 v[66:67], v61 offset:21504
    ds_read_b64_tr_b16 v[68:69], v60 offset:22528
    ds_read_b64_tr_b16 v[70:71], v60 offset:23552
    ds_read_b64_tr_b16 v[72:73], v61 offset:24576
    ds_read_b64_tr_b16 v[74:75], v61 offset:25600
    ds_read_b64_tr_b16 v[76:77], v60 offset:26624
    ds_read_b64_tr_b16 v[78:79], v60 offset:27648
    buffer_load_dwordx4 a[96:99], v2, s[28:31], s71 offen offset:0 sc1
    ds_read_b64_tr_b16 v[80:81], v61 offset:28672
    ds_read_b64_tr_b16 v[82:83], v61 offset:29696
    ds_read_b64_tr_b16 v[84:85], v60 offset:30720
    ds_read_b64_tr_b16 v[86:87], v60 offset:31744
    s_waitcnt lgkmcnt(12)
    v_mfma_f32_32x32x16_bf16 v[176:191], v[96:99], a[64:67], v[176:191]
    ds_read_b64_tr_b16 v[88:89], v61 offset:32768
    ds_read_b64_tr_b16 v[90:91], v61 offset:33792
    v_mul_f32 v208, v208, v4
    buffer_load_dwordx4 a[100:103], v2, s[28:31], s71 offen offset:1024 sc1
    v_mfma_f32_32x32x16_bf16 v[192:207], v[100:103], a[64:67], v[192:207]
    ds_read_b64_tr_b16 v[92:93], v60 offset:34816
    ds_read_b64_tr_b16 v[94:95], v60 offset:35840
    v_mul_f32 v209, v209, v4
    s_waitcnt lgkmcnt(12)
    v_mfma_f32_32x32x16_bf16 v[176:191], v[64:67], a[68:71], v[176:191]
    ds_read_b64_tr_b16 v[96:97], v61 offset:36864
    ds_read_b64_tr_b16 v[98:99], v61 offset:37888
    buffer_load_dwordx4 a[104:107], v2, s[28:31], s71 offen offset:2048 sc1
    v_mul_f32 v210, v210, v4
    v_mfma_f32_32x32x16_bf16 v[192:207], v[68:71], a[68:71], v[192:207]
    ds_read_b64_tr_b16 v[100:101], v60 offset:38912
    ds_read_b64_tr_b16 v[102:103], v60 offset:39936
    v_mul_f32 v211, v211, v4
    s_waitcnt lgkmcnt(12)
    v_mfma_f32_32x32x16_bf16 v[176:191], v[72:75], a[72:75], v[176:191]
    ds_read_b64_tr_b16 v[64:65], v61 offset:40960
    buffer_load_dwordx4 a[108:111], v2, s[28:31], s71 offen offset:3072 sc1
    s_mov_b32 s71, 12288
    ds_read_b64_tr_b16 v[66:67], v61 offset:41984
    v_mul_f32 v212, v212, v4
    v_mfma_f32_32x32x16_bf16 v[192:207], v[76:79], a[72:75], v[192:207]
    ds_read_b64_tr_b16 v[68:69], v60 offset:43008
    ds_read_b64_tr_b16 v[70:71], v60 offset:44032
    v_mul_f32 v213, v213, v4
    s_waitcnt lgkmcnt(12)
    v_mfma_f32_32x32x16_bf16 v[176:191], v[80:83], a[76:79], v[176:191]
    buffer_load_dwordx4 a[112:115], v2, s[28:31], s71 offen offset:0 sc1
    ds_read_b64_tr_b16 v[72:73], v61 offset:45056
    ds_read_b64_tr_b16 v[74:75], v61 offset:46080
    v_mul_f32 v214, v214, v4
    v_mfma_f32_32x32x16_bf16 v[192:207], v[84:87], a[76:79], v[192:207]
    ds_read_b64_tr_b16 v[76:77], v60 offset:47104
    ds_read_b64_tr_b16 v[78:79], v60 offset:48128
    v_mul_f32 v215, v215, v4
    s_waitcnt vmcnt(5)
    s_barrier
    buffer_load_dwordx4 a[116:119], v2, s[28:31], s71 offen offset:1024 sc1
    s_waitcnt lgkmcnt(12)
    v_mfma_f32_32x32x16_bf16 v[176:191], v[88:91], a[80:83], v[176:191]
    ds_read_b64_tr_b16 v[80:81], v61 offset:49216
    ds_read_b64_tr_b16 v[82:83], v61 offset:50240
    v_mul_f32 v216, v216, v4
    v_mfma_f32_32x32x16_bf16 v[192:207], v[92:95], a[80:83], v[192:207]
    ds_read_b64_tr_b16 v[84:85], v60 offset:51264
    buffer_load_dwordx4 a[120:123], v2, s[28:31], s71 offen offset:2048 sc1
    s_mov_b32 s71, 16384
    ds_read_b64_tr_b16 v[86:87], v60 offset:52288
    v_mul_f32 v217, v217, v4
    s_waitcnt lgkmcnt(12)
    v_mfma_f32_32x32x16_bf16 v[176:191], v[96:99], a[84:87], v[176:191]
    ds_read_b64_tr_b16 v[88:89], v61 offset:53312
    ds_read_b64_tr_b16 v[90:91], v61 offset:54336
    v_mul_f32 v218, v218, v4
    v_mfma_f32_32x32x16_bf16 v[192:207], v[100:103], a[84:87], v[192:207]
    buffer_load_dwordx4 a[124:127], v2, s[28:31], s71 offen offset:0 sc1
    ds_read_b64_tr_b16 v[92:93], v60 offset:55360
    ds_read_b64_tr_b16 v[94:95], v60 offset:56384
    v_mul_f32 v219, v219, v4
    s_waitcnt lgkmcnt(12)
    v_mfma_f32_32x32x16_bf16 v[176:191], v[64:67], a[88:91], v[176:191]
    ds_read_b64_tr_b16 v[96:97], v61 offset:57408
    ds_read_b64_tr_b16 v[98:99], v61 offset:58432
    v_mul_f32 v220, v220, v4
    v_mfma_f32_32x32x16_bf16 v[192:207], v[68:71], a[88:91], v[192:207]
    buffer_load_dwordx4 a[128:131], v2, s[28:31], s71 offen offset:1024 sc1
    ds_read_b64_tr_b16 v[100:101], v60 offset:59456
    ds_read_b64_tr_b16 v[102:103], v60 offset:60480
    v_mul_f32 v221, v221, v4
    s_waitcnt lgkmcnt(12)
    v_mfma_f32_32x32x16_bf16 v[176:191], v[72:75], a[92:95], v[176:191]
    ds_read_b64_tr_b16 v[64:65], v61 offset:61504
    ds_read_b64_tr_b16 v[66:67], v61 offset:62528
    v_mul_f32 v222, v222, v4
    v_mfma_f32_32x32x16_bf16 v[192:207], v[76:79], a[92:95], v[192:207]
    buffer_load_dwordx4 a[132:135], v2, s[28:31], s71 offen offset:2048 sc1
    ds_read_b64_tr_b16 v[68:69], v60 offset:63552
    ds_read_b64_tr_b16 v[70:71], v60 offset:64576
    v_mul_f32 v223, v223, v4
    s_waitcnt vmcnt(9)
    s_waitcnt lgkmcnt(12)
    v_mfma_f32_32x32x16_bf16 v[176:191], v[80:83], a[96:99], v[176:191]
    ds_read_b64_tr_b16 v[72:73], v63 offset:0
    ds_read_b64_tr_b16 v[74:75], v63 offset:1024
    v_mfma_f32_32x32x16_bf16 v[192:207], v[84:87], a[96:99], v[192:207]
    buffer_load_dwordx4 a[136:139], v2, s[28:31], s71 offen offset:3072 sc1
    s_mov_b32 s71, 20480
    ds_read_b64_tr_b16 v[76:77], v62 offset:2048
    ds_read_b64_tr_b16 v[78:79], v62 offset:3072
    s_waitcnt vmcnt(9)
    s_waitcnt lgkmcnt(12)
    v_mfma_f32_32x32x16_bf16 v[176:191], v[88:91], a[100:103], v[176:191]
    ds_read_b64_tr_b16 v[80:81], v63 offset:4096
    ds_read_b64_tr_b16 v[82:83], v63 offset:5120
    v_mfma_f32_32x32x16_bf16 v[192:207], v[92:95], a[100:103], v[192:207]
    buffer_load_dwordx4 a[140:143], v2, s[28:31], s71 offen offset:0 sc1
    ds_read_b64_tr_b16 v[84:85], v62 offset:6144
    ds_read_b64_tr_b16 v[86:87], v62 offset:7168
    s_waitcnt vmcnt(9)
    s_waitcnt lgkmcnt(12)
    v_mfma_f32_32x32x16_bf16 v[176:191], v[96:99], a[104:107], v[176:191]
    ds_read_b64_tr_b16 v[88:89], v63 offset:8192
    ds_read_b64_tr_b16 v[90:91], v63 offset:9216
    v_mfma_f32_32x32x16_bf16 v[192:207], v[100:103], a[104:107], v[192:207]
    buffer_load_dwordx4 a[144:147], v2, s[28:31], s71 offen offset:1024 sc1
    ds_read_b64_tr_b16 v[92:93], v62 offset:10240
    ds_read_b64_tr_b16 v[94:95], v62 offset:11264
    s_waitcnt vmcnt(9)
    s_waitcnt lgkmcnt(12)
    v_mfma_f32_32x32x16_bf16 v[176:191], v[64:67], a[108:111], v[176:191]
    ds_read_b64_tr_b16 v[96:97], v63 offset:16384
    ds_read_b64_tr_b16 v[98:99], v63 offset:17408
    v_mfma_f32_32x32x16_bf16 v[192:207], v[68:71], a[108:111], v[192:207]
    buffer_load_dwordx4 a[148:151], v2, s[28:31], s71 offen offset:2048 sc1
    ds_read_b64_tr_b16 v[100:101], v62 offset:18432
    ds_read_b64_tr_b16 v[102:103], v62 offset:19456
    s_waitcnt vmcnt(9)
    s_waitcnt lgkmcnt(12)
    v_mfma_f32_32x32x16_bf16 v[176:191], v[72:75], a[112:115], v[176:191]
    ds_read_b64_tr_b16 v[64:65], v63 offset:20480
    ds_read_b64_tr_b16 v[66:67], v63 offset:21504
    v_mfma_f32_32x32x16_bf16 v[192:207], v[76:79], a[112:115], v[192:207]
    ds_read_b64_tr_b16 v[68:69], v62 offset:22528
    ds_read_b64_tr_b16 v[70:71], v62 offset:23552
    s_waitcnt vmcnt(8)
    s_waitcnt lgkmcnt(12)
    v_mfma_f32_32x32x16_bf16 v[176:191], v[80:83], a[116:119], v[176:191]
    ds_read_b64_tr_b16 v[72:73], v63 offset:24576
    ds_read_b64_tr_b16 v[74:75], v63 offset:25600
    v_mfma_f32_32x32x16_bf16 v[192:207], v[84:87], a[116:119], v[192:207]
    ds_read_b64_tr_b16 v[76:77], v62 offset:26624
    ds_read_b64_tr_b16 v[78:79], v62 offset:27648
    s_waitcnt vmcnt(7)
    s_waitcnt lgkmcnt(12)
    v_mfma_f32_32x32x16_bf16 v[176:191], v[88:91], a[120:123], v[176:191]
    ds_read_b64_tr_b16 v[80:81], v63 offset:28672
    ds_read_b64_tr_b16 v[82:83], v63 offset:29696
    v_mfma_f32_32x32x16_bf16 v[192:207], v[92:95], a[120:123], v[192:207]
    ds_read_b64_tr_b16 v[84:85], v62 offset:30720
    ds_read_b64_tr_b16 v[86:87], v62 offset:31744
    s_waitcnt vmcnt(6)
    s_waitcnt lgkmcnt(12)
    v_mfma_f32_32x32x16_bf16 v[176:191], v[96:99], a[124:127], v[176:191]
    ds_read_b64_tr_b16 v[88:89], v7 offset:0
    ds_read_b64_tr_b16 v[90:91], v7 offset:1024
    v_mfma_f32_32x32x16_bf16 v[192:207], v[100:103], a[124:127], v[192:207]
    ds_read_b64_tr_b16 v[92:93], v6 offset:2048
    ds_read_b64_tr_b16 v[94:95], v6 offset:3072
    s_waitcnt vmcnt(5)
    s_waitcnt lgkmcnt(12)
    v_mfma_f32_32x32x16_bf16 v[176:191], v[64:67], a[128:131], v[176:191]
    ds_read_b64_tr_b16 v[96:97], v7 offset:4096
    ds_read_b64_tr_b16 v[98:99], v7 offset:5120
    v_mfma_f32_32x32x16_bf16 v[192:207], v[68:71], a[128:131], v[192:207]
    ds_read_b64_tr_b16 v[100:101], v6 offset:6144
    ds_read_b64_tr_b16 v[102:103], v6 offset:7168
    s_waitcnt vmcnt(4)
    s_waitcnt lgkmcnt(12)
    v_mfma_f32_32x32x16_bf16 v[176:191], v[72:75], a[132:135], v[176:191]
    ds_read_b64_tr_b16 v[64:65], v7 offset:8192
    ds_read_b64_tr_b16 v[66:67], v7 offset:9216
    v_mfma_f32_32x32x16_bf16 v[192:207], v[76:79], a[132:135], v[192:207]
    ds_read_b64_tr_b16 v[68:69], v6 offset:10240
    ds_read_b64_tr_b16 v[70:71], v6 offset:11264
    s_waitcnt vmcnt(3)
    s_waitcnt lgkmcnt(12)
    v_mfma_f32_32x32x16_bf16 v[176:191], v[80:83], a[136:139], v[176:191]
    ds_read_b64_tr_b16 v[72:73], v61 offset:18432
    ds_read_b64_tr_b16 v[74:75], v61 offset:19456
    v_mfma_f32_32x32x16_bf16 v[192:207], v[84:87], a[136:139], v[192:207]
    ds_read_b64_tr_b16 v[76:77], v61 offset:22528
    ds_read_b64_tr_b16 v[78:79], v61 offset:23552
    s_waitcnt vmcnt(2)
    s_waitcnt lgkmcnt(12)
    v_mfma_f32_32x32x16_bf16 v[176:191], v[88:91], a[140:143], v[176:191]
    ds_read_b64_tr_b16 v[80:81], v61 offset:26624
    ds_read_b64_tr_b16 v[82:83], v61 offset:27648
    v_mfma_f32_32x32x16_bf16 v[192:207], v[92:95], a[140:143], v[192:207]
    ds_read_b64_tr_b16 v[84:85], v61 offset:30720
    ds_read_b64_tr_b16 v[86:87], v61 offset:31744
    s_waitcnt vmcnt(1)
    s_waitcnt lgkmcnt(12)
    v_mfma_f32_32x32x16_bf16 v[176:191], v[96:99], a[144:147], v[176:191]
    ds_read_b64_tr_b16 v[88:89], v61 offset:34816
    ds_read_b64_tr_b16 v[90:91], v61 offset:35840
    v_mfma_f32_32x32x16_bf16 v[192:207], v[100:103], a[144:147], v[192:207]
    ds_read_b64_tr_b16 v[92:93], v61 offset:38912
    ds_read_b64_tr_b16 v[94:95], v61 offset:39936
    s_waitcnt vmcnt(0)
    s_waitcnt lgkmcnt(12)
    v_mfma_f32_32x32x16_bf16 v[176:191], v[64:67], a[148:151], v[176:191]
    ds_read_b64_tr_b16 v[96:97], v61 offset:43008
    ds_read_b64_tr_b16 v[98:99], v61 offset:44032
    v_mfma_f32_32x32x16_bf16 v[192:207], v[68:71], a[148:151], v[192:207]
    ds_read_b64_tr_b16 v[100:101], v61 offset:47104
    ds_read_b64_tr_b16 v[102:103], v61 offset:48128
    s_waitcnt lgkmcnt(12)
    v_mfma_f32_32x32x16_bf16 v[208:223], v[72:75], a[64:67], v[208:223]
    ds_read_b64_tr_b16 v[64:65], v61 offset:51264
    ds_read_b64_tr_b16 v[66:67], v61 offset:52288
    v_mfma_f32_32x32x16_bf16 v[208:223], v[76:79], a[68:71], v[208:223]
    ds_read_b64_tr_b16 v[68:69], v61 offset:55360
    ds_read_b64_tr_b16 v[70:71], v61 offset:56384
    s_waitcnt lgkmcnt(12)
    v_mfma_f32_32x32x16_bf16 v[208:223], v[80:83], a[72:75], v[208:223]
    ds_read_b64_tr_b16 v[72:73], v61 offset:59456
    ds_read_b64_tr_b16 v[74:75], v61 offset:60480
    v_mfma_f32_32x32x16_bf16 v[208:223], v[84:87], a[76:79], v[208:223]
    ds_read_b64_tr_b16 v[76:77], v61 offset:63552
    ds_read_b64_tr_b16 v[78:79], v61 offset:64576
    s_waitcnt lgkmcnt(12)
    v_mfma_f32_32x32x16_bf16 v[208:223], v[88:91], a[80:83], v[208:223]
    ds_read_b64_tr_b16 v[80:81], v63 offset:2048
    ds_read_b64_tr_b16 v[82:83], v63 offset:3072
    v_cvt_pk_bf16_f32 v176, v176, v177
    v_cvt_pk_bf16_f32 v177, v178, v179
    v_cvt_pk_bf16_f32 v178, v180, v181
    v_cvt_pk_bf16_f32 v179, v182, v183
    v_mfma_f32_32x32x16_bf16 v[208:223], v[92:95], a[84:87], v[208:223]
    ds_read_b64_tr_b16 v[84:85], v63 offset:6144
    ds_read_b64_tr_b16 v[86:87], v63 offset:7168
    buffer_store_dwordx4 v[176:179], v23, s[28:31], s52 offen offset:0 sc1
    v_cvt_pk_bf16_f32 v180, v184, v185
    v_cvt_pk_bf16_f32 v181, v186, v187
    s_waitcnt lgkmcnt(12)
    v_mfma_f32_32x32x16_bf16 v[208:223], v[96:99], a[88:91], v[208:223]
    ds_read_b64_tr_b16 v[88:89], v63 offset:10240
    ds_read_b64_tr_b16 v[90:91], v63 offset:11264
    v_cvt_pk_bf16_f32 v182, v188, v189
    v_cvt_pk_bf16_f32 v183, v190, v191
    buffer_store_dwordx4 v[180:183], v23, s[28:31], s52 offen offset:1024 sc1
    v_cvt_pk_bf16_f32 v192, v192, v193
    v_mfma_f32_32x32x16_bf16 v[208:223], v[100:103], a[92:95], v[208:223]
    ds_read_b64_tr_b16 v[92:93], v63 offset:18432
    ds_read_b64_tr_b16 v[94:95], v63 offset:19456
    v_cvt_pk_bf16_f32 v193, v194, v195
    v_cvt_pk_bf16_f32 v194, v196, v197
    v_cvt_pk_bf16_f32 v195, v198, v199
    s_waitcnt lgkmcnt(12)
    v_mfma_f32_32x32x16_bf16 v[208:223], v[64:67], a[96:99], v[208:223]
    ds_read_b64_tr_b16 v[96:97], v63 offset:22528
    ds_read_b64_tr_b16 v[98:99], v63 offset:23552
    buffer_store_dwordx4 v[192:195], v23, s[28:31], s53 offen offset:0 sc1
    v_cvt_pk_bf16_f32 v196, v200, v201
    v_cvt_pk_bf16_f32 v197, v202, v203
    v_cvt_pk_bf16_f32 v198, v204, v205
    v_mfma_f32_32x32x16_bf16 v[208:223], v[68:71], a[100:103], v[208:223]
    ds_read_b64_tr_b16 v[100:101], v63 offset:26624
    ds_read_b64_tr_b16 v[102:103], v63 offset:27648
    v_cvt_pk_bf16_f32 v199, v206, v207
    buffer_store_dwordx4 v[196:199], v23, s[28:31], s53 offen offset:1024 sc1
    s_waitcnt lgkmcnt(12)
    v_mfma_f32_32x32x16_bf16 v[208:223], v[72:75], a[104:107], v[208:223]
    ds_read_b64_tr_b16 v[64:65], v63 offset:30720
    ds_read_b64_tr_b16 v[66:67], v63 offset:31744
    v_mfma_f32_32x32x16_bf16 v[208:223], v[76:79], a[108:111], v[208:223]
    ds_read_b64_tr_b16 v[68:69], v7 offset:2048
    ds_read_b64_tr_b16 v[70:71], v7 offset:3072
    s_waitcnt lgkmcnt(12)
    v_mfma_f32_32x32x16_bf16 v[208:223], v[80:83], a[112:115], v[208:223]
    ds_read_b64_tr_b16 v[72:73], v7 offset:6144
    ds_read_b64_tr_b16 v[74:75], v7 offset:7168
    v_mfma_f32_32x32x16_bf16 v[208:223], v[84:87], a[116:119], v[208:223]
    ds_read_b64_tr_b16 v[76:77], v7 offset:10240
    ds_read_b64_tr_b16 v[78:79], v7 offset:11264
    s_waitcnt lgkmcnt(12)
    v_mfma_f32_32x32x16_bf16 v[208:223], v[88:91], a[120:123], v[208:223]
    ds_read_b64_tr_b16 v[80:81], v60 offset:16384
    ds_read_b64_tr_b16 v[82:83], v60 offset:17408
    v_mfma_f32_32x32x16_bf16 v[208:223], v[92:95], a[124:127], v[208:223]
    ds_read_b64_tr_b16 v[84:85], v60 offset:20480
    ds_read_b64_tr_b16 v[86:87], v60 offset:21504
    s_waitcnt lgkmcnt(12)
    v_mfma_f32_32x32x16_bf16 v[208:223], v[96:99], a[128:131], v[208:223]
    ds_read_b64_tr_b16 v[88:89], v60 offset:24576
    ds_read_b64_tr_b16 v[90:91], v60 offset:25600
    v_mfma_f32_32x32x16_bf16 v[208:223], v[100:103], a[132:135], v[208:223]
    ds_read_b64_tr_b16 v[92:93], v60 offset:28672
    ds_read_b64_tr_b16 v[94:95], v60 offset:29696
    s_waitcnt lgkmcnt(12)
    v_mfma_f32_32x32x16_bf16 v[208:223], v[64:67], a[136:139], v[208:223]
    ds_read_b64_tr_b16 v[96:97], v60 offset:32768
    ds_read_b64_tr_b16 v[98:99], v60 offset:33792
    v_mfma_f32_32x32x16_bf16 v[208:223], v[68:71], a[140:143], v[208:223]
    ds_read_b64_tr_b16 v[100:101], v60 offset:36864
    ds_read_b64_tr_b16 v[102:103], v60 offset:37888
    s_waitcnt lgkmcnt(12)
    v_mfma_f32_32x32x16_bf16 v[208:223], v[72:75], a[144:147], v[208:223]
    ds_read_b64_tr_b16 v[64:65], v60 offset:40960
    ds_read_b64_tr_b16 v[66:67], v60 offset:41984
    v_mfma_f32_32x32x16_bf16 v[208:223], v[76:79], a[148:151], v[208:223]
    ds_read_b64_tr_b16 v[68:69], v60 offset:45056
    ds_read_b64_tr_b16 v[70:71], v60 offset:46080
    s_waitcnt lgkmcnt(12)
    v_mfma_f32_32x32x16_bf16 v[160:175], v[80:83], a[64:67], 0
    ds_read_b64_tr_b16 v[72:73], v60 offset:49216
    ds_read_b64_tr_b16 v[74:75], v60 offset:50240
    v_mfma_f32_32x32x16_bf16 v[160:175], v[84:87], a[68:71], v[160:175]
    ds_read_b64_tr_b16 v[76:77], v60 offset:53312
    ds_read_b64_tr_b16 v[78:79], v60 offset:54336
    s_waitcnt lgkmcnt(12)
    v_mfma_f32_32x32x16_bf16 v[160:175], v[88:91], a[72:75], v[160:175]
    ds_read_b64_tr_b16 v[80:81], v60 offset:57408
    ds_read_b64_tr_b16 v[82:83], v60 offset:58432
    v_mfma_f32_32x32x16_bf16 v[160:175], v[92:95], a[76:79], v[160:175]
    ds_read_b64_tr_b16 v[84:85], v60 offset:61504
    ds_read_b64_tr_b16 v[86:87], v60 offset:62528
    s_waitcnt lgkmcnt(12)
    v_mfma_f32_32x32x16_bf16 v[160:175], v[96:99], a[80:83], v[160:175]
    ds_read_b64_tr_b16 v[88:89], v62 offset:0
    ds_read_b64_tr_b16 v[90:91], v62 offset:1024
    v_cvt_pk_bf16_f32 v208, v208, v209
    v_cvt_pk_bf16_f32 v209, v210, v211
    v_cvt_pk_bf16_f32 v210, v212, v213
    v_mfma_f32_32x32x16_bf16 v[160:175], v[100:103], a[84:87], v[160:175]
    ds_read_b64_tr_b16 v[92:93], v62 offset:4096
    ds_read_b64_tr_b16 v[94:95], v62 offset:5120
    v_cvt_pk_bf16_f32 v211, v214, v215
    buffer_store_dwordx4 v[208:211], v23, s[28:31], s80 offen offset:0 sc1
    v_cvt_pk_bf16_f32 v212, v216, v217
    s_waitcnt lgkmcnt(12)
    v_mfma_f32_32x32x16_bf16 v[160:175], v[64:67], a[88:91], v[160:175]
    ds_read_b64_tr_b16 v[96:97], v62 offset:8192
    ds_read_b64_tr_b16 v[98:99], v62 offset:9216
    v_cvt_pk_bf16_f32 v213, v218, v219
    v_cvt_pk_bf16_f32 v214, v220, v221
    v_cvt_pk_bf16_f32 v215, v222, v223
    v_mfma_f32_32x32x16_bf16 v[160:175], v[68:71], a[92:95], v[160:175]
    ds_read_b64_tr_b16 v[100:101], v62 offset:16384
    ds_read_b64_tr_b16 v[102:103], v62 offset:17408
    buffer_store_dwordx4 v[212:215], v23, s[28:31], s80 offen offset:1024 sc1
    s_waitcnt lgkmcnt(12)
    v_mfma_f32_32x32x16_bf16 v[160:175], v[72:75], a[96:99], v[160:175]
    ds_read_b64_tr_b16 v[64:65], v62 offset:20480
    ds_read_b64_tr_b16 v[66:67], v62 offset:21504
    v_mfma_f32_32x32x16_bf16 v[160:175], v[76:79], a[100:103], v[160:175]
    ds_read_b64_tr_b16 v[68:69], v62 offset:24576
    s_add_u32 s68, s82, 16
    s_add_u32 s63, s59, 8192
    s_add_u32 s64, s59, 16384
    ds_read_b64_tr_b16 v[70:71], v62 offset:25600
    s_lshl_b32 s69, s54, 2
    s_add_u32 s69, s69, s68
    s_waitcnt vmcnt(2)
    s_mov_b64 exec, 1
    buffer_store_dword v24, v23, s[28:31], s69 offen sc1
    s_mov_b64 exec, -1
    s_waitcnt lgkmcnt(12)
    v_mfma_f32_32x32x16_bf16 v[160:175], v[80:83], a[104:107], v[160:175]
    ds_read_b64_tr_b16 v[72:73], v62 offset:28672
    ds_read_b64_tr_b16 v[74:75], v62 offset:29696
    v_lshlrev_b32 v28, 16, v36
    v_and_b32 v29, s58, v36
    v_mfma_f32_32x32x16_bf16 v[160:175], v[84:87], a[108:111], v[160:175]
    ds_read_b64_tr_b16 v[76:77], v6 offset:0
    ds_read_b64_tr_b16 v[78:79], v6 offset:1024
    v_lshlrev_b32 v30, 16, v37
    s_waitcnt lgkmcnt(12)
    v_mfma_f32_32x32x16_bf16 v[160:175], v[88:91], a[112:115], v[160:175]
    ds_read_b64_tr_b16 v[80:81], v6 offset:4096
    ds_read_b64_tr_b16 v[82:83], v6 offset:5120
    v_and_b32 v31, s58, v37
    v_lshlrev_b32 v140, 16, v42
    v_mfma_f32_32x32x16_bf16 v[160:175], v[92:95], a[116:119], v[160:175]
    ds_read_b64_tr_b16 v[84:85], v6 offset:8192
    ds_read_b64_tr_b16 v[86:87], v6 offset:9216
    v_and_b32 v141, s58, v42
    s_waitcnt lgkmcnt(12)
    v_mfma_f32_32x32x16_bf16 v[160:175], v[96:99], a[120:123], v[160:175]
    ds_read_b128 v[88:91], v10 offset:0
    v_mul_f32 v140, v140, v28
    v_mfma_f32_32x32x16_bf16 v[160:175], v[100:103], a[124:127], v[160:175]
    ds_read_b128 v[92:95], v11 offset:0
    v_mul_f32 v141, v141, v29
    v_lshlrev_b32 v142, 16, v43
    s_waitcnt lgkmcnt(10)
    v_mfma_f32_32x32x16_bf16 v[160:175], v[64:67], a[128:131], v[160:175]
    ds_read_b128 v[96:99], v12 offset:0
    v_and_b32 v143, s58, v43
    v_mfma_f32_32x32x16_bf16 v[160:175], v[68:71], a[132:135], v[160:175]
    ds_read_b128 v[100:103], v13 offset:0
    v_mul_f32 v142, v142, v30
    s_waitcnt lgkmcnt(8)
    v_mfma_f32_32x32x16_bf16 v[160:175], v[72:75], a[136:139], v[160:175]
    ds_read_b128 v[64:67], v10 offset:16384
    v_mul_f32 v143, v143, v31
    v_lshlrev_b32 v144, 16, v44
    v_mfma_f32_32x32x16_bf16 v[160:175], v[76:79], a[140:143], v[160:175]
    ds_read_b128 v[68:71], v11 offset:16384
    v_and_b32 v145, s58, v44
    s_waitcnt lgkmcnt(6)
    v_mfma_f32_32x32x16_bf16 v[160:175], v[80:83], a[144:147], v[160:175]
    ds_read_b128 v[72:75], v12 offset:16384
    v_mul_f32 v144, v144, v28
    v_mul_f32 v145, v145, v29
    v_mfma_f32_32x32x16_bf16 v[160:175], v[84:87], a[148:151], v[160:175]
    ds_read_b128 v[76:79], v13 offset:16384
    v_lshlrev_b32 v146, 16, v45
    s_waitcnt lgkmcnt(6)
    v_mfma_f32_32x32x16_bf16 v[224:239], v[88:91], a[0:3], 0
    ds_read_b128 v[80:83], v10 offset:32768
    v_and_b32 v147, s58, v45
    v_mfma_f32_32x32x16_bf16 v[224:239], v[92:95], a[4:7], v[224:239]
    ds_read_b128 v[84:87], v11 offset:32768
    v_mul_f32 v146, v146, v30
    v_mul_f32 v147, v147, v31
    s_waitcnt lgkmcnt(6)
    v_mfma_f32_32x32x16_bf16 v[224:239], v[96:99], a[8:11], v[224:239]
    ds_read_b128 v[88:91], v12 offset:32768
    v_lshlrev_b32 v148, 16, v46
    v_mfma_f32_32x32x16_bf16 v[224:239], v[100:103], a[12:15], v[224:239]
    ds_read_b128 v[92:95], v13 offset:32768
    s_lshl_b32 s69, s54, 2
    s_add_u32 s69, s69, s82
    s_waitcnt vmcnt(1)
    s_mov_b64 exec, 1
    buffer_store_dword v24, v23, s[28:31], s69 offen sc1
    s_mov_b64 exec, -1
    s_load_dwordx4 s[20:23], s[28:29], s68 glc
    v_and_b32 v149, s58, v46
    v_mul_f32 v148, v148, v28
    s_waitcnt lgkmcnt(6)
    v_mfma_f32_32x32x16_bf16 v[224:239], v[64:67], a[16:19], v[224:239]
    ds_read_b128 v[96:99], v14 offset:0
    v_mul_f32 v149, v149, v29
    v_mfma_f32_32x32x16_bf16 v[224:239], v[68:71], a[20:23], v[224:239]
    ds_read_b128 v[100:103], v15 offset:0
    v_lshlrev_b32 v150, 16, v47
    s_waitcnt lgkmcnt(6)
    v_mfma_f32_32x32x16_bf16 v[224:239], v[72:75], a[24:27], v[224:239]
    ds_read_b128 v[64:67], v16 offset:0
    v_and_b32 v151, s58, v47
    v_mul_f32 v150, v150, v30
    v_mfma_f32_32x32x16_bf16 v[224:239], v[76:79], a[28:31], v[224:239]
    ds_read_b128 v[68:71], v17 offset:0
    v_mul_f32 v151, v151, v31
    s_waitcnt lgkmcnt(6)
    v_mfma_f32_32x32x16_bf16 v[224:239], v[80:83], a[32:35], v[224:239]
    v_lshlrev_b32 v152, 16, v48
    v_and_b32 v153, s58, v48
    v_mfma_f32_32x32x16_bf16 v[224:239], v[84:87], a[36:39], v[224:239]
    v_mul_f32 v152, v152, v28
    s_waitcnt lgkmcnt(4)
    v_mfma_f32_32x32x16_bf16 v[224:239], v[88:91], a[40:43], v[224:239]
    v_mul_f32 v153, v153, v29
    v_mfma_f32_32x32x16_bf16 v[224:239], v[92:95], a[44:47], v[224:239]
    v_lshlrev_b32 v154, 16, v49
    v_and_b32 v155, s58, v49
    s_waitcnt lgkmcnt(2)
    v_mfma_f32_32x32x16_bf16 v[224:239], v[96:99], a[48:51], v[224:239]
    v_mul_f32 v154, v154, v30
    v_mfma_f32_32x32x16_bf16 v[224:239], v[100:103], a[52:55], v[224:239]
    s_waitcnt lgkmcnt(0)
    s_add_u32 s20, s20, s21
    s_add_u32 s20, s20, s22
    s_add_u32 s20, s20, s23
    s_mul_i32 s21, s62, 4
    s_cmp_eq_u32 s20, s21
    s_mov_b32 s81, 0
    s_cbranch_scc1 L_pP12_ok
L_pP12:
    s_sleep 1
    s_add_u32 s81, s81, 1
    s_cmp_gt_u32 s81, 200000
    s_cbranch_scc1 L_pP12_ok
    s_load_dwordx4 s[20:23], s[28:29], s68 glc
    s_waitcnt lgkmcnt(0)
    s_add_u32 s20, s20, s21
    s_add_u32 s20, s20, s22
    s_add_u32 s20, s20, s23
    s_mul_i32 s21, s62, 4
    s_cmp_eq_u32 s20, s21
    s_cbranch_scc0 L_pP12
L_pP12_ok:
    buffer_load_dwordx4 v[104:107], v23, s[28:31], s59 offen offset:0 sc1
    v_mul_f32 v155, v155, v31
    v_mfma_f32_32x32x16_bf16 v[224:239], v[64:67], a[56:59], v[224:239]
    v_lshlrev_b32 v34, 1, v32
    s_lshl_b32 s76, s65, 16
    v_mfma_f32_32x32x16_bf16 v[224:239], v[68:71], a[60:63], v[224:239]
    s_add_u32 s77, s76, 16384
    buffer_load_dwordx4 v[108:111], v23, s[28:31], s59 offen offset:1024 sc1
    s_nop 7
    s_nop 3
    v_fma_f32 v160, v224, v4, v160
    buffer_load_dwordx4 v[112:115], v23, s[28:31], s63 offen offset:0 sc1
    v_fma_f32 v161, v225, v4, v161
    v_fma_f32 v162, v226, v4, v162
    v_fma_f32 v163, v227, v4, v163
    v_fma_f32 v164, v228, v4, v164
    v_fma_f32 v165, v229, v4, v165
    v_fma_f32 v166, v230, v4, v166
    v_fma_f32 v167, v231, v4, v167
    v_fma_f32 v168, v232, v4, v168
    v_fma_f32 v169, v233, v4, v169
    v_fma_f32 v170, v234, v4, v170
    buffer_load_dwordx4 v[116:119], v23, s[28:31], s63 offen offset:1024 sc1
    v_fma_f32 v171, v235, v4, v171
    v_fma_f32 v172, v236, v4, v172
    v_fma_f32 v173, v237, v4, v173
    v_fma_f32 v174, v238, v4, v174
    v_fma_f32 v175, v239, v4, v175
    s_load_dwordx4 s[24:27], s[28:29], s82 glc
    s_waitcnt lgkmcnt(0)
    s_add_u32 s24, s24, s25
    s_add_u32 s24, s24, s26
    s_add_u32 s24, s24, s27
    s_mul_i32 s25, s62, 4
    s_cmp_eq_u32 s24, s25
    s_mov_b32 s81, 0
    s_cbranch_scc1 L_pP_ok
L_pP:
    s_sleep 1
    s_add_u32 s81, s81, 1
    s_cmp_gt_u32 s81, 200000
    s_cbranch_scc1 L_pP_ok
    s_load_dwordx4 s[24:27], s[28:29], s82 glc
    s_waitcnt lgkmcnt(0)
    s_add_u32 s24, s24, s25
    s_add_u32 s24, s24, s26
    s_add_u32 s24, s24, s27
    s_mul_i32 s25, s62, 4
    s_cmp_eq_u32 s24, s25
    s_cbranch_scc0 L_pP
L_pP_ok:
    buffer_load_dwordx4 v[120:123], v23, s[28:31], s64 offen offset:0 sc1
    buffer_load_dwordx4 v[124:127], v23, s[28:31], s64 offen offset:1024 sc1
    v_mov_b32 v28, 0x3f80
    v_mov_b32 v29, 1.0
    s_waitcnt vmcnt(4)
    v_dot2_f32_bf16 v160, v104, v28, v160
    v_dot2_f32_bf16 v161, v104, v29, v161
    v_dot2_f32_bf16 v162, v105, v28, v162
    v_dot2_f32_bf16 v163, v105, v29, v163
    v_dot2_f32_bf16 v164, v106, v28, v164
    v_dot2_f32_bf16 v165, v106, v29, v165
    v_dot2_f32_bf16 v166, v107, v28, v166
    v_dot2_f32_bf16 v167, v107, v29, v167
    v_dot2_f32_bf16 v168, v108, v28, v168
    v_dot2_f32_bf16 v169, v108, v29, v169
    v_dot2_f32_bf16 v170, v109, v28, v170
    v_dot2_f32_bf16 v171, v109, v29, v171
    v_dot2_f32_bf16 v172, v110, v28, v172
    v_dot2_f32_bf16 v173, v110, v29, v173
    v_dot2_f32_bf16 v174, v111, v28, v174
    v_dot2_f32_bf16 v175, v111, v29, v175
    s_waitcnt vmcnt(2)
    v_dot2_f32_bf16 v160, v112, v28, v160
    v_dot2_f32_bf16 v161, v112, v29, v161
    v_dot2_f32_bf16 v162, v113, v28, v162
    v_dot2_f32_bf16 v163, v113, v29, v163
    v_dot2_f32_bf16 v164, v114, v28, v164
    v_dot2_f32_bf16 v165, v114, v29, v165
    v_dot2_f32_bf16 v166, v115, v28, v166
    v_dot2_f32_bf16 v167, v115, v29, v167
    v_dot2_f32_bf16 v168, v116, v28, v168
    v_dot2_f32_bf16 v169, v116, v29, v169
    v_dot2_f32_bf16 v170, v117, v28, v170
    v_dot2_f32_bf16 v171, v117, v29, v171
    v_dot2_f32_bf16 v172, v118, v28, v172
    v_dot2_f32_bf16 v173, v118, v29, v173
    v_dot2_f32_bf16 v174, v119, v28, v174
    v_dot2_f32_bf16 v175, v119, v29, v175
    s_waitcnt vmcnt(0)
    v_dot2_f32_bf16 v160, v120, v28, v160
    v_dot2_f32_bf16 v161, v120, v29, v161
    v_dot2_f32_bf16 v162, v121, v28, v162
    v_dot2_f32_bf16 v163, v121, v29, v163
    v_dot2_f32_bf16 v164, v122, v28, v164
    v_dot2_f32_bf16 v165, v122, v29, v165
    v_dot2_f32_bf16 v166, v123, v28, v166
    v_dot2_f32_bf16 v167, v123, v29, v167
    ds_write_b128 v132, v[160:163]
    v_dot2_f32_bf16 v168, v124, v28, v168
    v_dot2_f32_bf16 v169, v124, v29, v169
    v_dot2_f32_bf16 v170, v125, v28, v170
    v_dot2_f32_bf16 v171, v125, v29, v171
    ds_write_b128 v133, v[164:167]
    v_dot2_f32_bf16 v172, v126, v28, v172
    v_dot2_f32_bf16 v173, v126, v29, v173
    v_dot2_f32_bf16 v174, v127, v28, v174
    v_dot2_f32_bf16 v175, v127, v29, v175
    ds_write_b128 v134, v[168:171]
    s_nop 1
    ds_write_b128 v135, v[172:175]
    ds_read_b128 v[176:179], v136
    ds_read_b128 v[180:183], v137
    ds_read_b128 v[184:187], v138
    ds_read_b128 v[188:191], v139
    s_waitcnt lgkmcnt(3)
    v_fma_f32 v140, v140, v128, v176
    v_fma_f32 v141, v141, v128, v177
    v_fma_f32 v142, v142, v128, v178
    v_fma_f32 v143, v143, v128, v179
    buffer_store_dwordx4 v[140:143], v34, s[48:51], s76 offen offset:0
    s_waitcnt lgkmcnt(2)
    v_fma_f32 v144, v144, v129, v180
    v_fma_f32 v145, v145, v129, v181
    v_fma_f32 v146, v146, v129, v182
    v_fma_f32 v147, v147, v129, v183
    buffer_store_dwordx4 v[144:147], v34, s[48:51], s77 offen offset:0
    s_waitcnt lgkmcnt(1)
    v_fma_f32 v148, v148, v130, v184
    v_fma_f32 v149, v149, v130, v185
    v_fma_f32 v150, v150, v130, v186
    v_fma_f32 v151, v151, v130, v187
    buffer_store_dwordx4 v[148:151], v34, s[48:51], s76 offen offset:2048
    s_waitcnt lgkmcnt(0)
    v_fma_f32 v152, v152, v131, v188
    v_fma_f32 v153, v153, v131, v189
    v_fma_f32 v154, v154, v131, v190
    v_fma_f32 v155, v155, v131, v191
    buffer_store_dwordx4 v[152:155], v34, s[48:51], s77 offen offset:2048
    s_cmp_lg_u32 s4, 15
    s_cbranch_scc1 L_noep
    s_cmp_lg_u32 s5, 0
    s_cbranch_scc1 L_noep
    s_cmp_lg_u32 s3, 0
    s_cbranch_scc1 L_noep
    s_mov_b32 s70, 13631488
    s_mov_b64 exec, 1
    buffer_store_dword v24, v23, s[28:31], s70 offen sc1
    s_mov_b64 exec, -1
L_noep:
L_end:
    s_endpgm
.section .rodata,"a"
.p2align 6
.amdhsa_kernel gated_mix__ssm_conv_s5__glu_gated_bilinear__prompt_kernel
  .amdhsa_next_free_vgpr 512
  .amdhsa_next_free_sgpr 102
  .amdhsa_accum_offset 256
  .amdhsa_group_segment_fixed_size 0
  .amdhsa_kernarg_size 136
  .amdhsa_user_sgpr_count 2
  .amdhsa_user_sgpr_kernarg_segment_ptr 1
  .amdhsa_system_sgpr_workgroup_id_x 1
  .amdhsa_float_denorm_mode_32 3
  .amdhsa_float_denorm_mode_16_64 3
.end_amdhsa_kernel
```
